```python
import torch

def _softmax(x, axis=-1):
    return torch.softmax(x, dim=axis)
def _gelu(x):
    return torch.nn.functional.gelu(x, approximate="tanh")
def _silu(x):
    return torch.nn.functional.silu(x)
def _sigmoid(x):
    return torch.sigmoid(x)
def _layernorm(x, axis=-1, eps=1e-5):
    m = x.mean(dim=axis, keepdim=True)
    v = x.var(dim=axis, keepdim=True, unbiased=False)
    return (x - m) / torch.sqrt(v + eps)
def _scatter_add(tgt, idx, src, axis=0):
    return tgt.clone().index_add_(axis, idx, src)
def _segment_sum(src, seg, n):
    out = torch.zeros((n,) + src.shape[1:], dtype=src.dtype)
    return out.index_add_(0, seg, src)
def _pad(x, pw):
    flat = tuple(v for pair in reversed(pw) for v in pair)
    return torch.nn.functional.pad(x, flat)

kernel_name = 'parallel_sum__sliding_local_dilated__moe_arch_mod__prompt'

def setup_inputs():

    _w = (lambda a: (lambda t: t.to(torch.bfloat16) if t.is_floating_point() else t)(torch.as_tensor(a)))
    def _A_setup():
        B, S, D = 1, 2048, 1024
        return {
            "x": _w((lambda *s: torch.randn(*s, dtype=torch.bfloat16) * 0.05)(B, S, D)),
            "wqkv": _w((lambda *s: torch.randn(*s, dtype=torch.bfloat16) * 0.05)(D, 3 * D)),
            "wo": _w((lambda *s: torch.randn(*s, dtype=torch.bfloat16) * 0.05)(D, D)),
        }
    _A_in = _A_setup()

    def _B_setup():
        B, S, D, F, C = 1, 2048, 1024, 3584, 8
        return {
            "x": _w((lambda *s: torch.randn(*s, dtype=torch.bfloat16) * 0.05)(B, S, D)),
            "w_r": _w((lambda *s: torch.randn(*s, dtype=torch.bfloat16) * 0.05)(D)),
            "w_gate": _w((lambda *s: torch.randn(*s, dtype=torch.bfloat16) * 0.05)(D, F)),
            "w_up": _w((lambda *s: torch.randn(*s, dtype=torch.bfloat16) * 0.05)(D, F)),
            "w_down": _w((lambda *s: torch.randn(*s, dtype=torch.bfloat16) * 0.05)(F, D)),
        }
    _B_in = _B_setup()

    return {
        "A_x": _A_in["x"],
        "A_wqkv": _A_in["wqkv"],
        "A_wo": _A_in["wo"],
        "B_x": _B_in["x"],
        "B_w_r": _B_in["w_r"],
        "B_w_gate": _B_in["w_gate"],
        "B_w_up": _B_in["w_up"],
        "B_w_down": _B_in["w_down"],
    }

def reference(A_x, A_wqkv, A_wo, B_x, B_w_r, B_w_gate, B_w_up, B_w_down):
    def _A_ref(x, wqkv, wo):
        B, S, D = x.shape
        H = 32; Dh = D // H
        W, dil = 8, 2
        qkv = (lambda x, *d: x.permute(*d))((x @ wqkv).reshape(B, S, 3, H, Dh), 2, 0, 3, 1, 4)
        q, k, v = qkv[0], qkv[1], qkv[2]
        scale = Dh ** -0.5
        pos = torch.arange(S)
        off = torch.arange(W) * dil
        idx = pos[:, None] - off[None, :]
        mask = idx >= 0
        idx_c = torch.where(mask, idx, 0).reshape(-1)
        kg = k[:, :, idx_c, :].reshape(B, H, S, W, Dh)
        vg = v[:, :, idx_c, :].reshape(B, H, S, W, Dh)
        logits = torch.einsum("bhsd,bhswd->bhsw", q, kg) * scale
        logits = torch.where(mask[None, None, :, :], logits, -1e9)
        attn = _softmax(logits, axis=-1)
        o = torch.einsum("bhsw,bhswd->bhsd", attn, vg)
        return (lambda x, *d: x.permute(*d))(o, 0, 2, 1, 3).reshape(B, S, D) @ wo

    def _B_ref(x, w_r, w_gate, w_up, w_down):
        B, S, D = x.shape
        C = 8
        r = x @ w_r
        idx = torch.argsort(-r, axis=-1)[:, :C]
        idx_e = (lambda x, n, axis: torch.repeat_interleave(x, n, dim=axis))(idx.reshape(B, C, 1), D, axis=2)
        x_sel = (lambda x, i, axis: torch.take_along_dim(x, i, dim=axis))(x, idx_e, axis=1)
        g = _silu(x_sel @ w_gate)
        u = x_sel @ w_up
        y = (g * u) @ w_down
        r_sel = _sigmoid((lambda x, i, axis: torch.take_along_dim(x, i, dim=axis))(r, idx, axis=1))
        y = y * r_sel.reshape(B, C, 1)
        b_off = (torch.arange(B) * S).reshape(B, 1)
        flat_idx = (idx + b_off).reshape(B * C)
        zero = (x * 0.0).reshape(B * S, D)
        upd = _scatter_add(zero, flat_idx, y.reshape(B * C, D), axis=0)
        return x + upd.reshape(B, S, D)

    x = A_x
    xn = _layernorm(x, axis=-1)
    return x + _A_ref(xn, A_wqkv, A_wo) + _B_ref(xn, B_w_r, B_w_gate, B_w_up, B_w_down)
```

```asm
; @launch grid=(256,1,1) block=(512,1,1) lds=163840
.amdgcn_target "amdgcn-amd-amdhsa--gfx950"
.text
.globl parallel_sum__sliding_local_dilated__moe_arch_mod__prompt_kernel
.p2align 8
.type parallel_sum__sliding_local_dilated__moe_arch_mod__prompt_kernel,@function
parallel_sum__sliding_local_dilated__moe_arch_mod__prompt_kernel:
    s_cmp_ge_u32 s2, 256
    s_cbranch_scc1 L_end0
    s_load_dwordx16 s[4:19], s[0:1], 0
    s_load_dwordx2 s[20:21], s[0:1], 64
    s_load_dwordx2 s[22:23], s[0:1], 80
    s_getpc_b64 s[50:51]
L_pc:
    v_cmp_gt_u32 vcc, 160, v0
    v_lshlrev_b32 v2, 7, v0
    s_and_saveexec_b64 s[48:49], vcc
    s_cbranch_execz L_nopf
    global_load_dword v208, v2, s[50:51]
L_nopf:
    s_mov_b64 exec, s[48:49]
    v_lshrrev_b32 v1, 6, v0
    v_and_b32 v0, 63, v0
    v_readfirstlane_b32 s3, v1
    s_and_b32 s24, s2, 1
    s_lshl_b32 s24, s24, 3
    s_bfe_u32 s48, s2, 0x30003
    s_add_u32 s24, s24, s48
    s_bfe_u32 s25, s2, 0x20001
    s_lshl_b32 s25, s25, 2
    s_lshr_b32 s48, s2, 6
    s_add_u32 s25, s25, s48
    s_mov_b32 s34, 4194304
    s_mov_b32 s35, 0x20000
    s_mov_b32 s43, s35
    s_cmp_lt_u32 s3, 2
    s_cbranch_scc1 L_loader
    s_sub_u32 s57, s3, 4
    s_lshl_b32 s49, s3, 1
    s_cmp_ge_u32 s3, 4
    s_cselect_b32 s57, s57, s49
    s_cselect_b32 s56, 1, 2
    s_lshl_b32 s49, s24, 4
    s_add_u32 s49, s49, s25
    s_lshl_b32 s59, s49, 3
    s_add_u32 s48, s59, s57
    s_lshl_b32 s48, s48, 11
    v_lshlrev_b32 v1, 4, v0
    s_movk_i32 s42, 2048
    s_waitcnt lgkmcnt(0)
    s_mov_b32 s32, s4
    s_and_b32 s33, s5, 0xffff
    buffer_load_dwordx4 v[132:135], v1, s[32:35], s48 offen
    buffer_load_dwordx4 v[136:139], v1, s[32:35], s48 offen offset:1024
    s_mov_b32 s40, s12
    s_and_b32 s41, s13, 0xffff
    buffer_load_dwordx4 v[140:143], v1, s[40:43], 0 offen
    buffer_load_dwordx4 v[144:147], v1, s[40:43], 0 offen offset:1024
    s_branch L_notloader
L_end0:
    s_endpgm
L_loader:
    v_lshrrev_b32 v2, 3, v0
    v_and_b32 v3, 7, v0
    s_lshl_b32 s49, s3, 3
    v_add_u32 v4, s49, v2
    v_lshrrev_b32 v5, 1, v4
    v_xor_b32 v5, v5, v3
    v_lshlrev_b32 v6, 11, v4
    v_lshl_add_u32 v11, v5, 4, v6
    s_lshl_b32 s48, s24, 18
    v_add_u32 v11, s48, v11
    v_subrev_u32 v10, 32768, v11
    s_lshl_b32 s48, s25, 7
    v_add_u32 v6, s48, v6
    v_mul_u32_u24 v8, 43, v4
    v_mov_b64 v[14:15], 0
    v_mov_b64 v[16:17], 0
    v_mov_b32 v18, 0
    v_lshrrev_b32 v7, 7, v8
    v_lshrrev_b32 v5, 8, v8
    v_and_b32 v5, 4, v5
    v_and_or_b32 v5, v7, 2, v5
    v_xor_b32 v5, v5, v3
    v_lshl_add_u32 v12, v5, 4, v6
    v_add_u32 v8, 688, v8
    v_lshrrev_b32 v7, 7, v8
    v_lshrrev_b32 v5, 8, v8
    v_and_b32 v5, 4, v5
    v_and_or_b32 v5, v7, 2, v5
    v_xor_b32 v5, v5, v3
    v_lshl_add_u32 v13, v5, 4, v6
    v_add_u32 v8, 688, v8
    v_lshrrev_b32 v7, 7, v8
    v_lshrrev_b32 v5, 8, v8
    v_and_b32 v5, 4, v5
    v_and_or_b32 v5, v7, 2, v5
    v_xor_b32_e64 v5, v5, v3
    v_lshl_add_u32 v14, v5, 4, v6
    s_and_b32 s50, s24, 7
    s_mul_i32 s50, s50, 8
    s_lshr_b32 s51, s24, 3
    s_mul_i32 s51, s51, 4
    s_add_u32 s50, s50, s51
    s_and_b32 s51, s25, 3
    s_mul_i32 s51, s51, 8
    s_add_u32 s50, s50, s51
    s_lshr_b32 s51, s25, 2
    s_mul_i32 s51, s51, 2
    s_add_u32 s50, s50, s51
    s_and_b32 s50, s50, 15
    s_mul_i32 s51, s50, 393216
    s_lshl_b32 s50, s50, 7
    s_lshl_b32 s52, s3, 10
    s_add_u32 s52, s52, 2048
    s_add_u32 s53, s52, 129024
    s_mov_b32 s54, 0
    s_mov_b32 s42, 6291456
    s_mov_b32 s46, 7340032
    s_mov_b32 s47, s35
    s_waitcnt lgkmcnt(0)
    s_mov_b32 s32, s4
    s_and_b32 s33, s5, 0xffff
    s_mov_b32 s40, s6
    s_and_b32 s41, s7, 0xffff
    s_cmp_eq_u32 s3, 0
    s_cselect_b32 s44, s14, s16
    s_cselect_b32 s45, s15, s17
    s_and_b32 s45, s45, 0xffff
L_ld_loop:
    s_add_u32 m0, s52, 18432
    s_add_u32 s48, s51, 0
    buffer_load_dwordx4 v12, s[40:43], s48 offen lds
    s_add_u32 m0, s52, 0
    s_add_u32 s48, s50, 0
    buffer_load_dwordx4 v10, s[32:35], s48 offen lds
    s_add_u32 m0, s52, 20480
    s_add_u32 s48, s51, 32768
    buffer_load_dwordx4 v13, s[40:43], s48 offen lds
    s_add_u32 m0, s52, 2048
    s_add_u32 s48, s50, 0
    s_nop 0
    buffer_load_dwordx4 v11, s[32:35], s48 offen lds
    s_add_u32 m0, s52, 22528
    s_add_u32 s48, s51, 65536
    buffer_load_dwordx4 v14, s[40:43], s48 offen lds
    s_add_u32 m0, s52, 4096
    s_add_u32 s48, s50, 32768
    buffer_load_dwordx4 v11, s[32:35], s48 offen lds
    s_add_u32 m0, s52, 24576
    s_add_u32 s48, s51, 98304
    buffer_load_dwordx4 v12, s[40:43], s48 offen lds
    s_add_u32 m0, s52, 26624
    s_add_u32 s48, s51, 131072
    buffer_load_dwordx4 v13, s[40:43], s48 offen lds
    s_add_u32 m0, s52, 6144
    s_add_u32 s48, s50, 65536
    buffer_load_dwordx4 v11, s[32:35], s48 offen lds
    s_add_u32 m0, s52, 28672
    s_add_u32 s48, s51, 163840
    buffer_load_dwordx4 v14, s[40:43], s48 offen lds
    s_add_u32 m0, s52, 8192
    s_add_u32 s48, s50, 98304
    buffer_load_dwordx4 v11, s[32:35], s48 offen lds
    s_add_u32 m0, s52, 30720
    s_add_u32 s48, s51, 196608
    buffer_load_dwordx4 v12, s[40:43], s48 offen lds
    s_add_u32 m0, s52, 10240
    s_add_u32 s48, s50, 131072
    buffer_load_dwordx4 v11, s[32:35], s48 offen lds
    s_add_u32 m0, s52, 32768
    s_add_u32 s48, s51, 229376
    buffer_load_dwordx4 v13, s[40:43], s48 offen lds
    s_add_u32 m0, s52, 34816
    s_add_u32 s48, s51, 262144
    buffer_load_dwordx4 v14, s[40:43], s48 offen lds
    s_add_u32 m0, s52, 12288
    s_add_u32 s48, s50, 163840
    buffer_load_dwordx4 v11, s[32:35], s48 offen lds
    s_add_u32 m0, s52, 36864
    s_add_u32 s48, s51, 294912
    buffer_load_dwordx4 v12, s[40:43], s48 offen lds
    s_add_u32 m0, s52, 14336
    s_add_u32 s48, s50, 196608
    buffer_load_dwordx4 v11, s[32:35], s48 offen lds
    s_add_u32 m0, s52, 38912
    s_add_u32 s48, s51, 327680
    buffer_load_dwordx4 v13, s[40:43], s48 offen lds
    s_add_u32 m0, s52, 16384
    s_add_u32 s48, s50, 229376
    buffer_load_dwordx4 v11, s[32:35], s48 offen lds
    s_add_u32 m0, s52, 40960
    s_add_u32 s48, s51, 360448
    buffer_load_dwordx4 v14, s[40:43], s48 offen lds
    s_add_u32 s50, s50, 128
    s_add_u32 s51, s51, 393216
    s_and_b32 s50, s50, 2047
    s_cselect_b32 s51, s51, 0
    s_add_u32 s52, s52, 43008
    s_cmp_eq_u32 s52, s53
    s_cselect_b32 s48, 129024, 0
    s_sub_u32 s52, s52, s48
    s_add_u32 s54, s54, 1
    s_cmp_eq_u32 s54, 1
    s_cbranch_scc1 L_ld_setup
    s_cmp_lg_u32 s62, s54
    s_cbranch_scc1 L_ld_w21
    s_mov_b32 m0, s63
    s_add_u32 s62, s62, 2
    s_add_u32 s64, s64, 1
    s_cmp_eq_u32 s64, 4
    s_cselect_b32 s62, 0, s62
    buffer_load_dwordx4 v15, s[44:47], s60 offen nt lds
    s_add_u32 m0, m0, s65
    s_add_u32 s60, s60, s61
    buffer_load_dwordx4 v16, s[44:47], s60 offen nt lds
    s_add_u32 m0, m0, s65
    s_add_u32 s60, s60, s61
    buffer_load_dwordx4 v15, s[44:47], s60 offen nt lds
    s_add_u32 m0, m0, s65
    s_add_u32 s60, s60, s61
    buffer_load_dwordx4 v16, s[44:47], s60 offen nt lds
    s_add_u32 m0, m0, s65
    s_add_u32 s60, s60, s61
    buffer_load_dwordx4 v15, s[44:47], s60 offen nt lds
    s_add_u32 m0, m0, s65
    s_add_u32 s60, s60, s61
    buffer_load_dwordx4 v16, s[44:47], s60 offen nt lds
    s_add_u32 m0, m0, s65
    s_add_u32 s60, s60, s61
    buffer_load_dwordx4 v15, s[44:47], s60 offen nt lds
    s_add_u32 m0, m0, s65
    s_add_u32 s60, s60, s61
    buffer_load_dwordx4 v16, s[44:47], s60 offen nt lds
    s_add_u32 m0, m0, s65
    s_add_u32 s60, s60, s61
    s_xor_b32 s63, s63, 8192
    s_wakeup
    s_waitcnt vmcnt(29)
    s_branch L_ld_bar
L_ld_w21:
    s_wakeup
    s_waitcnt vmcnt(21)
L_ld_bar:
    s_barrier
    s_cmp_lt_u32 s54, 16
    s_cbranch_scc1 L_ld_loop
    s_mov_b32 s44, s8
    s_and_b32 s45, s9, 0xffff
    s_mov_b32 s46, 2097152
    s_mov_b32 s47, 0x20000
L_wo_loop:
    s_sub_u32 s50, s52, 2048
    s_lshl_b32 s50, s50, 4
    s_mov_b32 m0, s52
    s_mov_b32 s51, 3
L_wo_in:
    buffer_load_dwordx4 v18, s[44:47], s50 offen lds
    s_add_u32 m0, m0, s66
    s_add_u32 s50, s50, s67
    buffer_load_dwordx4 v18, s[44:47], s50 offen lds
    s_add_u32 m0, m0, s66
    s_add_u32 s50, s50, s67
    buffer_load_dwordx4 v18, s[44:47], s50 offen lds
    s_add_u32 m0, m0, s66
    s_add_u32 s50, s50, s67
    buffer_load_dwordx4 v18, s[44:47], s50 offen lds
    s_add_u32 m0, m0, s66
    s_add_u32 s50, s50, s67
    buffer_load_dwordx4 v18, s[44:47], s50 offen lds
    s_add_u32 m0, m0, s66
    s_add_u32 s50, s50, s67
    buffer_load_dwordx4 v18, s[44:47], s50 offen lds
    s_add_u32 m0, m0, s66
    s_add_u32 s50, s50, s67
    buffer_load_dwordx4 v18, s[44:47], s50 offen lds
    s_add_u32 m0, m0, s66
    s_add_u32 s50, s50, s67
    s_sub_u32 s51, s51, 1
    s_cmp_lg_u32 s51, 0
    s_cbranch_scc1 L_wo_in
    s_add_u32 s52, s52, 43008
    s_cmp_eq_u32 s52, s53
    s_cselect_b32 s48, 129024, 0
    s_sub_u32 s52, s52, s48
    s_add_u32 s54, s54, 1
    s_cmp_eq_u32 s54, 19
    s_cbranch_scc1 L_wo_end
    s_wakeup
    s_waitcnt vmcnt(21)
    s_barrier
    s_branch L_wo_loop
L_wo_end:
    s_mov_b32 m0, s53
    s_sub_u32 s50, s53, 2048
    s_lshl_b32 s50, s50, 4
    buffer_load_dwordx4 v18, s[44:47], s50 offen lds
    s_mov_b32 s29, 0x100000
    v_and_b32 v4, 3, v0
    v_lshlrev_b32 v4, 2, v4
    s_lshl_b32 s48, s24, 18
    v_subrev_u32 v11, s48, v11
    s_lshl_b32 s50, s26, 18
    s_lshl_b32 s48, s27, 7
    s_add_u32 s50, s50, s48
    s_lshl_b32 s52, s3, 10
    s_add_u32 s52, s52, 133120
L_lw_1:
    ds_read_b32 v6, v4 offset:160
    s_waitcnt lgkmcnt(0)
    v_cmp_gt_u32 vcc, 1, v6
    s_cbranch_vccz L_lwe_2
    s_sleep 1
    s_sub_u32 s29, s29, 1
    s_cbranch_scc1 L_end
    s_branch L_lw_1
L_lwe_2:
    s_add_u32 m0, s52, 0
    s_add_u32 s48, s50, 0
    buffer_load_dwordx4 v11, s[32:35], s48 offen lds
    s_add_u32 m0, s52, 2048
    s_add_u32 s48, s50, 32768
    buffer_load_dwordx4 v11, s[32:35], s48 offen lds
    s_add_u32 m0, s52, 14336
    s_add_u32 s48, s50, 65536
    buffer_load_dwordx4 v11, s[32:35], s48 offen lds
    s_add_u32 m0, s52, 16384
    s_add_u32 s48, s50, 98304
    buffer_load_dwordx4 v11, s[32:35], s48 offen lds
    s_add_u32 m0, s52, 4096
    s_add_u32 s48, s50, 131072
    buffer_load_dwordx4 v11, s[32:35], s48 offen lds
    s_add_u32 m0, s52, 6144
    s_add_u32 s48, s50, 163840
    buffer_load_dwordx4 v11, s[32:35], s48 offen lds
    s_add_u32 m0, s52, 18432
    s_add_u32 s48, s50, 196608
    buffer_load_dwordx4 v11, s[32:35], s48 offen lds
    s_add_u32 m0, s52, 20480
    s_add_u32 s48, s50, 229376
    buffer_load_dwordx4 v11, s[32:35], s48 offen lds
    s_mov_b32 s36, s22
    s_and_b32 s37, s23, 0xffff
    s_mov_b32 s38, 12582912
    s_mov_b32 s39, 0x20000
    v_and_b32 v4, 15, v0
    v_lshlrev_b32 v4, 8, v4
    s_lshl_b32 s48, s26, 12
    s_add_u32 s48, s48, 196608
    v_mov_b32 v5, 0
    ds_read_b32 v8, v5 offset:1504
    s_waitcnt vmcnt(0)
    ds_write_b32 v7, v9
    s_cmp_lg_u32 s3, 0
    s_cbranch_scc1 L_ld_end
    s_setprio 3
    s_mov_b32 s50, 0
L_ld_poll:
    s_andn2_b32 exec_lo, 0xffff, s50
    s_mov_b32 exec_hi, 0
    buffer_load_dword v6, v4, s[36:39], s48 offen sc1
    s_waitcnt vmcnt(0) lgkmcnt(0)
    v_cmp_eq_u32 vcc, v8, v6
    s_or_b32 s50, s50, vcc_lo
    s_lshr_b32 s51, s50, 1
    s_and_b32 s51, s51, s50
    s_and_b32 s51, s51, 0x5555
    s_mul_i32 s51, s51, 0x10001
    s_mov_b64 exec, 1
    v_mov_b32 v9, s51
    ds_write_b32 v5, v9 offset:156
    s_cmp_eq_u32 s50, 0xffff
    s_cbranch_scc1 L_ld_end
    s_sleep 6
    s_sub_u32 s29, s29, 1
    s_cbranch_scc1 L_end
    s_branch L_ld_poll
L_ld_end:
    s_endpgm
L_ld_setup:
    s_and_b32 s26, s24, 8
    s_bfe_u32 s48, s2, 0x10001
    s_lshl_b32 s48, s48, 2
    s_add_u32 s26, s26, s48
    s_bfe_u32 s48, s2, 0x20003
    s_add_u32 s26, s26, s48
    s_bfe_u32 s27, s2, 0x10002
    s_lshl_b32 s27, s27, 3
    s_lshr_b32 s48, s2, 5
    s_add_u32 s27, s27, s48
    s_and_b32 s48, s25, 7
    s_cmp_lg_u32 s48, 3
    s_cselect_b32 s69, 1, 0
    s_add_u32 s48, s25, 4
    s_lshr_b32 s48, s48, 3
    s_sub_u32 s48, s25, s48
    s_lshl_b32 s48, s48, 4
    s_add_u32 s58, s48, s24
    s_lshr_b32 s56, s58, 2
    s_and_b32 s57, s58, 3
    v_and_b32 v7, 2, v2
    v_xor_b32 v7, v7, v3
    v_mul_u32_u24 v15, 7168, v2
    v_lshl_add_u32 v15, v7, 4, v15
    v_xor_b32 v16, 64, v15
    v_and_b32 v7, 6, v2
    v_xor_b32 v7, v7, v3
    v_lshlrev_b32 v5, 11, v2
    v_lshl_add_u32 v17, v7, 4, v5
    s_lshl_b32 s48, s27, 7
    v_add_u32 v18, s48, v17
    s_mul_i32 s60, s57, 1835008
    s_and_b32 s48, s3, 1
    s_xor_b32 s48, s48, s56
    s_lshl_b32 s48, s48, 7
    s_add_u32 s60, s60, s48
    s_mov_b32 s61, 57344
    s_mov_b32 s64, 0
    s_movk_i32 s65, 1024
    s_lshr_b32 s62, s2, 4
    s_and_b32 s62, s62, 1
    s_add_u32 s62, s62, 4
    s_mul_i32 s62, s62, s69
    s_lshl_b32 s63, s3, 14
    s_add_u32 s63, s63, 131072
    s_movk_i32 s66, 2048
    s_mov_b32 s67, 32768
    s_lshl_b32 s48, s3, 2
    s_add_u32 s48, s48, 128
    v_lshlrev_b32 v7, 2, v0
    v_add_u32 v7, 1536, v7
    v_writelane_b32 v7, s48, 0
    v_mov_b32 v9, 1
    s_branch L_ld_loop
L_notloader:
    s_load_dword s28, s[22:23], 0
    s_mov_b32 s36, s22
    s_and_b32 s37, s23, 0xffff
    s_mov_b32 s38, 12582912
    s_mov_b32 s39, 0x20000
    s_mov_b32 s29, 0x100000
    s_cmp_ge_u32 s3, 4
    s_cbranch_scc1 L_c_setup
    buffer_load_dwordx4 v[200:203], v1, s[32:35], s48 offen offset:2048
    buffer_load_dwordx4 v[204:207], v1, s[32:35], s48 offen offset:3072
    v_lshlrev_b32 v2, 2, v0
    v_mov_b32 v3, 0x3f803f80
    v_cmp_gt_u32 vcc, 32, v0
    s_nop 1
    v_cndmask_b32 v3, 0, v3, vcc
    ds_write_b32 v2, v3
    s_sub_u32 s3, s3, 2
    s_waitcnt vmcnt(2)
    s_branch L_stats
L_c_setup:
    s_sub_u32 s3, s3, 4
    s_and_b32 s30, s3, 1
    s_lshr_b32 s31, s3, 1
    v_mov_b64 v[16:17], 0
    v_mov_b64 v[18:19], 0
    v_mov_b64 v[20:21], 0
    v_mov_b64 v[22:23], 0
    v_mov_b64 v[24:25], 0
    v_mov_b64 v[26:27], 0
    v_mov_b64 v[28:29], 0
    v_mov_b64 v[30:31], 0
    v_mov_b64 v[32:33], 0
    v_mov_b64 v[34:35], 0
    v_mov_b64 v[36:37], 0
    v_mov_b64 v[38:39], 0
    v_mov_b64 v[40:41], 0
    v_mov_b64 v[42:43], 0
    v_mov_b64 v[44:45], 0
    v_mov_b64 v[46:47], 0
    v_mov_b64 v[48:49], 0
    v_mov_b64 v[50:51], 0
    v_mov_b64 v[52:53], 0
    v_mov_b64 v[54:55], 0
    v_mov_b64 v[56:57], 0
    v_mov_b64 v[58:59], 0
    v_mov_b64 v[60:61], 0
    v_mov_b64 v[62:63], 0
    v_mov_b64 v[64:65], 0
    v_mov_b64 v[66:67], 0
    v_mov_b64 v[68:69], 0
    v_mov_b64 v[70:71], 0
    v_mov_b64 v[72:73], 0
    v_mov_b64 v[74:75], 0
    v_mov_b64 v[76:77], 0
    v_mov_b64 v[78:79], 0
    v_mov_b64 v[80:81], 0
    v_mov_b64 v[82:83], 0
    v_mov_b64 v[84:85], 0
    v_mov_b64 v[86:87], 0
    v_mov_b64 v[88:89], 0
    v_mov_b64 v[90:91], 0
    v_mov_b64 v[92:93], 0
    v_mov_b64 v[94:95], 0
    v_mov_b64 v[96:97], 0
    v_mov_b64 v[98:99], 0
    v_mov_b64 v[100:101], 0
    v_mov_b64 v[102:103], 0
    v_mov_b64 v[104:105], 0
    v_mov_b64 v[106:107], 0
    v_mov_b64 v[108:109], 0
    v_mov_b64 v[110:111], 0
    v_mov_b64 v[112:113], 0
    v_mov_b64 v[114:115], 0
    v_mov_b64 v[116:117], 0
    v_mov_b64 v[118:119], 0
    v_mov_b64 v[120:121], 0
    v_mov_b64 v[122:123], 0
    v_mov_b64 v[124:125], 0
    v_mov_b64 v[126:127], 0
    v_and_b32 v2, 15, v0
    v_lshrrev_b32 v3, 4, v0
    v_lshrrev_b32 v4, 1, v2
    v_xor_b32 v4, v4, v3
    v_lshlrev_b32 v4, 4, v4
    v_lshl_add_u32 v4, v2, 7, v4
    v_cmp_ne_u32 vcc, 0, v2
    s_nop 1
    v_cndmask_b32 v10, 0, -1, vcc
    v_and_b32 v6, 2048, v10
    v_add_u32 v6, v6, v4
    v_xor_b32 v7, 64, v6
    s_lshl_b32 s48, s31, 13
    s_add_u32 s48, s48, 4096
    v_add_u32 v4, s48, v4
    v_xor_b32 v5, 64, v4
    v_lshrrev_b32 v8, 4, v0
    v_bfe_u32 v9, v0, 2, 2
    v_lshl_add_u32 v8, v8, 3, v9
    v_lshlrev_b32 v8, 7, v8
    v_and_b32 v9, 3, v0
    v_lshl_add_u32 v8, v9, 3, v8
    v_bfe_u32 v9, v0, 3, 2
    v_lshl_add_u32 v8, v9, 5, v8
    v_lshrrev_b32 v9, 7, v8
    v_lshl_add_u32 v8, v9, 8, v8
    s_lshl_b32 s48, s30, 6
    v_xor_b32 v8, s48, v8
    v_add_u32 v8, 20480, v8
    v_xor_b32 v9, 32, v8
    s_waitcnt vmcnt(0)
L_stats:
    v_lshlrev_b32 v148, 16, v132
    v_and_b32 v149, 0xffff0000, v132
    v_lshlrev_b32 v150, 16, v133
    v_and_b32 v151, 0xffff0000, v133
    v_lshlrev_b32 v152, 16, v134
    v_and_b32 v153, 0xffff0000, v134
    v_lshlrev_b32 v154, 16, v135
    v_and_b32 v155, 0xffff0000, v135
    v_lshlrev_b32 v156, 16, v136
    v_and_b32 v157, 0xffff0000, v136
    v_lshlrev_b32 v158, 16, v137
    v_and_b32 v159, 0xffff0000, v137
    v_lshlrev_b32 v160, 16, v138
    v_and_b32 v161, 0xffff0000, v138
    v_lshlrev_b32 v162, 16, v139
    v_and_b32 v163, 0xffff0000, v139
    v_pk_add_f32 v[164:165], v[148:149], v[150:151]
    v_pk_add_f32 v[166:167], v[152:153], v[154:155]
    v_pk_add_f32 v[168:169], v[156:157], v[158:159]
    v_pk_add_f32 v[170:171], v[160:161], v[162:163]
    v_pk_add_f32 v[164:165], v[164:165], v[166:167]
    v_pk_add_f32 v[168:169], v[168:169], v[170:171]
    v_pk_add_f32 v[164:165], v[164:165], v[168:169]
    v_add_f32 v180, v164, v165
    s_nop 1
    v_add_f32_dpp v180, v180, v180 quad_perm:[1,0,3,2] row_mask:0xf bank_mask:0xf
    s_nop 1
    v_add_f32_dpp v180, v180, v180 quad_perm:[2,3,0,1] row_mask:0xf bank_mask:0xf
    s_nop 1
    v_add_f32_dpp v180, v180, v180 row_half_mirror row_mask:0xf bank_mask:0xf
    s_nop 1
    v_add_f32_dpp v180, v180, v180 row_mirror row_mask:0xf bank_mask:0xf
    v_mov_b32 v181, v180
    s_nop 1
    v_permlane16_swap_b32 v181, v180
    v_add_f32 v180, v180, v181
    v_mov_b32 v181, v180
    s_nop 1
    v_permlane32_swap_b32 v181, v180
    v_add_f32_e64 v180, v180, v181
    v_mul_f32 v180, 0x3a800000, v180
    v_pk_add_f32 v[164:165], v[148:149], v[180:181] op_sel_hi:[1,0] neg_lo:[0,1] neg_hi:[0,1]
    v_pk_add_f32 v[166:167], v[150:151], v[180:181] op_sel_hi:[1,0] neg_lo:[0,1] neg_hi:[0,1]
    v_pk_add_f32 v[168:169], v[152:153], v[180:181] op_sel_hi:[1,0] neg_lo:[0,1] neg_hi:[0,1]
    v_pk_add_f32 v[170:171], v[154:155], v[180:181] op_sel_hi:[1,0] neg_lo:[0,1] neg_hi:[0,1]
    v_pk_add_f32 v[172:173], v[156:157], v[180:181] op_sel_hi:[1,0] neg_lo:[0,1] neg_hi:[0,1]
    v_pk_add_f32 v[174:175], v[158:159], v[180:181] op_sel_hi:[1,0] neg_lo:[0,1] neg_hi:[0,1]
    v_pk_add_f32 v[176:177], v[160:161], v[180:181] op_sel_hi:[1,0] neg_lo:[0,1] neg_hi:[0,1]
    v_pk_add_f32 v[178:179], v[162:163], v[180:181] op_sel_hi:[1,0] neg_lo:[0,1] neg_hi:[0,1]
    v_pk_mul_f32 v[182:183], v[164:165], v[164:165]
    v_pk_mul_f32 v[184:185], v[166:167], v[166:167]
    v_pk_fma_f32 v[182:183], v[168:169], v[168:169], v[182:183]
    v_pk_fma_f32 v[184:185], v[170:171], v[170:171], v[184:185]
    v_pk_fma_f32 v[182:183], v[172:173], v[172:173], v[182:183]
    v_pk_fma_f32 v[184:185], v[174:175], v[174:175], v[184:185]
    v_pk_fma_f32 v[182:183], v[176:177], v[176:177], v[182:183]
    v_pk_fma_f32 v[184:185], v[178:179], v[178:179], v[184:185]
    v_pk_add_f32 v[182:183], v[182:183], v[184:185]
    v_add_f32 v182, v182, v183
    v_cvt_pk_bf16_f32 v180, v180, v180
    v_lshlrev_b32 v180, 16, v180
    v_add_f32_dpp v182, v182, v182 quad_perm:[1,0,3,2] row_mask:0xf bank_mask:0xf
    v_pk_add_f32 v[164:165], v[148:149], v[180:181] op_sel_hi:[1,0] neg_lo:[0,1] neg_hi:[0,1]
    v_pk_add_f32 v[166:167], v[150:151], v[180:181] op_sel_hi:[1,0] neg_lo:[0,1] neg_hi:[0,1]
    v_add_f32_dpp v182, v182, v182 quad_perm:[2,3,0,1] row_mask:0xf bank_mask:0xf
    v_pk_add_f32 v[168:169], v[152:153], v[180:181] op_sel_hi:[1,0] neg_lo:[0,1] neg_hi:[0,1]
    v_pk_add_f32 v[170:171], v[154:155], v[180:181] op_sel_hi:[1,0] neg_lo:[0,1] neg_hi:[0,1]
    v_add_f32_dpp v182, v182, v182 row_half_mirror row_mask:0xf bank_mask:0xf
    v_pk_add_f32 v[172:173], v[156:157], v[180:181] op_sel_hi:[1,0] neg_lo:[0,1] neg_hi:[0,1]
    v_pk_add_f32 v[174:175], v[158:159], v[180:181] op_sel_hi:[1,0] neg_lo:[0,1] neg_hi:[0,1]
    v_add_f32_dpp v182, v182, v182 row_mirror row_mask:0xf bank_mask:0xf
    v_pk_add_f32 v[176:177], v[160:161], v[180:181] op_sel_hi:[1,0] neg_lo:[0,1] neg_hi:[0,1]
    v_pk_add_f32 v[178:179], v[162:163], v[180:181] op_sel_hi:[1,0] neg_lo:[0,1] neg_hi:[0,1]
    v_mov_b32 v183, v182
    v_cvt_pk_bf16_f32 v132, v164, v165
    v_cvt_pk_bf16_f32 v133, v166, v167
    v_permlane16_swap_b32 v183, v182
    v_add_f32 v182, v182, v183
    v_mov_b32 v183, v182
    v_cvt_pk_bf16_f32 v134, v168, v169
    v_cvt_pk_bf16_f32 v135, v170, v171
    v_permlane32_swap_b32 v183, v182
    v_add_f32 v182, v182, v183
    v_mul_f32 v182, 0x3a800000, v182
    v_cvt_pk_bf16_f32 v182, v182, v182
    v_lshlrev_b32 v182, 16, v182
    v_add_f32 v182, 0x3727c5ac, v182
    v_cvt_pk_bf16_f32 v182, v182, v182
    v_lshlrev_b32 v182, 16, v182
    v_sqrt_f32_e64 v182, v182
    v_cvt_pk_bf16_f32 v136, v172, v173
    v_cvt_pk_bf16_f32 v137, v174, v175
    v_cvt_pk_bf16_f32 v138, v176, v177
    v_cvt_pk_bf16_f32 v139, v178, v179
    v_cvt_pk_bf16_f32 v182, v182, v182
    v_lshlrev_b32 v182, 16, v182
    v_rcp_f32 v184, v182
    v_lshlrev_b32 v164, 16, v132
    v_and_b32 v165, 0xffff0000, v132
    v_lshlrev_b32 v166, 16, v133
    v_and_b32 v167, 0xffff0000, v133
    v_lshlrev_b32 v168, 16, v134
    v_and_b32 v169, 0xffff0000, v134
    v_lshlrev_b32 v170, 16, v135
    v_and_b32 v171, 0xffff0000, v135
    v_lshlrev_b32 v172, 16, v136
    v_and_b32 v173, 0xffff0000, v136
    v_lshlrev_b32 v174, 16, v137
    v_and_b32 v175, 0xffff0000, v137
    v_lshlrev_b32 v176, 16, v138
    v_and_b32 v177, 0xffff0000, v138
    v_lshlrev_b32 v178, 16, v139
    v_and_b32 v179, 0xffff0000, v139
    v_pk_mul_f32 v[164:165], v[164:165], v[184:185] op_sel_hi:[1,0]
    v_pk_mul_f32 v[166:167], v[166:167], v[184:185] op_sel_hi:[1,0]
    v_pk_mul_f32 v[168:169], v[168:169], v[184:185] op_sel_hi:[1,0]
    v_pk_mul_f32 v[170:171], v[170:171], v[184:185] op_sel_hi:[1,0]
    v_pk_mul_f32 v[172:173], v[172:173], v[184:185] op_sel_hi:[1,0]
    v_pk_mul_f32 v[174:175], v[174:175], v[184:185] op_sel_hi:[1,0]
    v_pk_mul_f32 v[176:177], v[176:177], v[184:185] op_sel_hi:[1,0]
    v_pk_mul_f32 v[178:179], v[178:179], v[184:185] op_sel_hi:[1,0]
    v_cvt_pk_bf16_f32 v132, v164, v165
    v_cvt_pk_bf16_f32 v133, v166, v167
    v_cvt_pk_bf16_f32 v134, v168, v169
    v_cvt_pk_bf16_f32 v135, v170, v171
    v_cvt_pk_bf16_f32 v136, v172, v173
    v_cvt_pk_bf16_f32 v137, v174, v175
    v_cvt_pk_bf16_f32 v138, v176, v177
    v_cvt_pk_bf16_f32 v139, v178, v179
    v_mov_b32 v186, 0
    v_lshrrev_b32 v187, 16, v182
    v_or_b32 v187, v187, v180
    v_dot2c_f32_bf16 v186, v132, v140
    v_dot2c_f32_bf16 v186, v133, v141
    v_dot2c_f32_bf16 v186, v134, v142
    v_dot2c_f32_bf16 v186, v135, v143
    v_dot2c_f32_bf16 v186, v136, v144
    v_dot2c_f32_bf16 v186, v137, v145
    v_dot2c_f32_bf16 v186, v138, v146
    v_dot2c_f32_bf16 v186, v139, v147
    s_add_u32 s48, s59, s57
    s_sub_u32 s48, 2047, s48
    s_lshl_b32 s49, s57, 3
    v_mov_b32 v184, s49
    v_add_f32_dpp v186, v186, v186 quad_perm:[1,0,3,2] row_mask:0xf bank_mask:0xf
    s_nop 1
    v_add_f32_dpp v186, v186, v186 quad_perm:[2,3,0,1] row_mask:0xf bank_mask:0xf
    s_nop 1
    v_add_f32_dpp v186, v186, v186 row_half_mirror row_mask:0xf bank_mask:0xf
    s_nop 1
    v_add_f32_dpp v186, v186, v186 row_mirror row_mask:0xf bank_mask:0xf
    v_mov_b32 v185, v186
    s_nop 1
    v_permlane16_swap_b32 v185, v186
    v_add_f32 v186, v186, v185
    v_mov_b32 v185, v186
    s_nop 1
    v_permlane32_swap_b32 v185, v186
    v_add_f32 v186, v186, v185
    v_cvt_pk_bf16_f32 v186, v186, v186
    v_ashrrev_i32 v185, 31, v186
    v_or_b32 v185, 0x80000000, v185
    v_xor_b32 v186, v186, v185
    v_and_b32 v186, 0xffff0000, v186
    v_or_b32 v186, s48, v186
    s_mov_b64 exec, 1
    ds_write_b64 v184, v[186:187] offset:1440
    s_mov_b64 exec, -1
    s_cmp_eq_u32 s56, 1
    s_cbranch_scc1 L_cons
    s_cmp_eq_u32 s56, 0
    s_cbranch_scc1 L_ffn
    s_waitcnt vmcnt(0)
    v_mov_b64 v[132:133], v[200:201]
    v_mov_b64 v[134:135], v[202:203]
    v_mov_b64 v[136:137], v[204:205]
    v_mov_b64 v[138:139], v[206:207]
    s_mov_b32 s56, 0
    s_add_u32 s57, s57, 1
    s_branch L_stats
    s_nop 0
L_cons:
    s_mov_b32 s55, 43008
    s_mov_b32 s52, 0
    s_mov_b32 s53, 0
    s_setprio 2
    s_waitcnt lgkmcnt(0)
    s_barrier
    ds_read_b128 v[128:131], v6
    ds_read_b64_tr_b16 v[156:157], v8 offset:128
    ds_read_b64_tr_b16 v[158:159], v8 offset:1664
    ds_read_b64_tr_b16 v[160:161], v9 offset:128
    ds_read_b64_tr_b16 v[162:163], v9 offset:1664
    ds_read_b128 v[144:147], v4 offset:6144
    ds_read_b64_tr_b16 v[164:165], v8 offset:256
    ds_read_b64_tr_b16 v[166:167], v8 offset:1792
    ds_read_b64_tr_b16 v[168:169], v9 offset:256
    ds_read_b64_tr_b16 v[170:171], v9 offset:1792
    ds_read_b128 v[132:135], v4 offset:0
    ds_read_b64_tr_b16 v[148:149], v8 offset:0
    ds_read_b64_tr_b16 v[150:151], v8 offset:1536
    ds_read_b128 v[136:139], v4 offset:2048
    ds_read_b64_tr_b16 v[152:153], v9 offset:0
    ds_read_b64_tr_b16 v[154:155], v9 offset:1536
    ds_read_b128 v[140:143], v4 offset:4096
    s_and_b32 s26, s24, 8
    s_bfe_u32 s48, s2, 0x10001
    s_lshl_b32 s48, s48, 2
    s_add_u32 s26, s26, s48
    s_bfe_u32 s48, s2, 0x20003
    s_add_u32 s26, s26, s48
    s_bfe_u32 s27, s2, 0x10002
    s_lshl_b32 s27, s27, 3
    s_lshr_b32 s48, s2, 5
    s_add_u32 s27, s27, s48
    v_lshrrev_b32 v12, 3, v0
    v_lshrrev_b32 v13, 4, v0
    v_xor_b32 v13, v13, v0
    v_and_b32 v13, 7, v13
    v_lshlrev_b32 v12, 11, v12
    v_lshl_add_u32 v12, v13, 4, v12
    v_xor_b32 v13, 64, v12
    s_lshl_b32 s58, s26, 2
    s_add_u32 s58, s58, s3
    s_lshl_b32 s56, s58, 16
    s_lshl_b32 s48, s27, 7
    s_add_u32 s56, s56, s48
    s_lshl_b32 s59, s58, 8
    s_add_u32 s59, s59, 131072
    s_lshl_b32 s68, s24, 4
    s_add_u32 s68, s68, s25
    s_lshl_b32 s68, s68, 8
    s_add_u32 s68, s68, 196608
    s_lshl_b32 s48, s24, 1
    s_add_u32 s48, s48, s31
    s_lshl_b32 s48, s48, 6
    s_add_u32 s48, s48, s25
    s_lshl_b32 s48, s48, 1
    s_add_u32 s48, s48, s30
    s_lshl_b32 s48, s48, 10
    s_add_u32 s69, s48, 8388608
    s_add_u32 s70, s48, 8421376
    s_add_u32 s71, s48, 8454144
    s_add_u32 s72, s48, 8486912
    s_cmp_eq_u32 s31, 1
    s_cbranch_scc1 L_c_loop1
L_c_loop0:
    s_waitcnt lgkmcnt(0)
    v_mfma_f32_16x16x32_bf16 v[48:51], v[156:159], v[128:131], v[48:51]
    ds_read_b128 v[172:175], v7
    s_add_u32 s52, s52, 1
    v_mfma_f32_16x16x32_bf16 v[52:55], v[160:163], v[128:131], v[52:55]
    ds_read_b64_tr_b16 v[200:201], v8 offset:12416
    s_cmp_eq_u32 s52, 3
    v_mfma_f32_16x16x32_bf16 v[88:91], v[148:151], v[128:131], v[88:91]
    ds_read_b64_tr_b16 v[202:203], v8 offset:13952
    s_cselect_b32 s52, 0, s52
    v_mfma_f32_16x16x32_bf16 v[80:83], v[156:159], v[144:147], v[80:83]
    ds_read_b64_tr_b16 v[204:205], v9 offset:12416
    s_cselect_b32 s54, 4294881280, s55
    v_mfma_f32_16x16x32_bf16 v[84:87], v[160:163], v[144:147], v[84:87]
    ds_read_b64_tr_b16 v[206:207], v9 offset:13952
    s_add_u32 s53, s53, 1
    v_mfma_f32_16x16x32_bf16 v[120:123], v[144:147], v[164:167], v[120:123]
    ds_read_b128 v[188:191], v5 offset:6144
    v_mfma_f32_16x16x32_bf16 v[124:127], v[144:147], v[168:171], v[124:127]
    ds_read_b64_tr_b16 v[208:209], v8 offset:12544
    v_mfma_f32_16x16x32_bf16 v[56:59], v[156:159], v[132:135], v[56:59]
    ds_read_b64_tr_b16 v[210:211], v8 offset:14080
    v_mfma_f32_16x16x32_bf16 v[60:63], v[160:163], v[132:135], v[60:63]
    ds_read_b64_tr_b16 v[212:213], v9 offset:12544
    v_mfma_f32_16x16x32_bf16 v[96:99], v[132:135], v[164:167], v[96:99]
    ds_read_b64_tr_b16 v[214:215], v9 offset:14080
    v_mfma_f32_16x16x32_bf16 v[100:103], v[132:135], v[168:171], v[100:103]
    ds_read_b128 v[176:179], v5 offset:0
    v_mfma_f32_16x16x32_bf16 v[64:67], v[156:159], v[136:139], v[64:67]
    ds_read_b64_tr_b16 v[192:193], v8 offset:12288
    v_mfma_f32_16x16x32_bf16 v[68:71], v[160:163], v[136:139], v[68:71]
    ds_read_b64_tr_b16 v[194:195], v8 offset:13824
    v_mfma_f32_16x16x32_bf16 v[104:107], v[136:139], v[164:167], v[104:107]
    ds_read_b128 v[180:183], v5 offset:2048
    v_mfma_f32_16x16x32_bf16 v[108:111], v[136:139], v[168:171], v[108:111]
    ds_read_b64_tr_b16 v[196:197], v9 offset:12288
    v_mfma_f32_16x16x32_bf16 v[72:75], v[156:159], v[140:143], v[72:75]
    ds_read_b64_tr_b16 v[198:199], v9 offset:13824
    v_mfma_f32_16x16x32_bf16 v[76:79], v[160:163], v[140:143], v[76:79]
    ds_read_b128 v[184:187], v5 offset:4096
    v_mfma_f32_16x16x32_bf16 v[112:115], v[140:143], v[164:167], v[112:115]
    v_add_u32 v8, s54, v8
    v_add_u32 v9, s54, v9
    v_mfma_f32_16x16x32_bf16 v[116:119], v[140:143], v[168:171], v[116:119]
    v_and_b32 v15, s54, v10
    v_add_u32 v4, s54, v4
    v_mfma_f32_16x16x32_bf16 v[16:19], v[148:151], v[132:135], v[16:19]
    v_add_u32 v6, v15, v6
    s_cmp_eq_u32 s53, 16
    v_mfma_f32_16x16x32_bf16 v[20:23], v[152:155], v[132:135], v[20:23]
    v_mfma_f32_16x16x32_bf16 v[24:27], v[148:151], v[136:139], v[24:27]
    v_mfma_f32_16x16x32_bf16 v[28:31], v[152:155], v[136:139], v[28:31]
    v_mfma_f32_16x16x32_bf16 v[32:35], v[148:151], v[140:143], v[32:35]
    v_mfma_f32_16x16x32_bf16 v[36:39], v[152:155], v[140:143], v[36:39]
    v_mfma_f32_16x16x32_bf16 v[40:43], v[148:151], v[144:147], v[40:43]
    s_cbranch_scc1 L_c_last0
    s_waitcnt lgkmcnt(0)
    s_barrier
    v_mfma_f32_16x16x32_bf16 v[44:47], v[152:155], v[144:147], v[44:47]
    v_mfma_f32_16x16x32_bf16 v[48:51], v[200:203], v[172:175], v[48:51]
    ds_read_b128 v[128:131], v6
    v_mfma_f32_16x16x32_bf16 v[52:55], v[204:207], v[172:175], v[52:55]
    ds_read_b64_tr_b16 v[156:157], v8 offset:128
    v_mfma_f32_16x16x32_bf16 v[88:91], v[192:195], v[172:175], v[88:91]
    ds_read_b64_tr_b16 v[158:159], v8 offset:1664
    v_mfma_f32_16x16x32_bf16 v[80:83], v[200:203], v[188:191], v[80:83]
    ds_read_b64_tr_b16 v[160:161], v9 offset:128
    v_mfma_f32_16x16x32_bf16 v[84:87], v[204:207], v[188:191], v[84:87]
    ds_read_b64_tr_b16 v[162:163], v9 offset:1664
    v_mfma_f32_16x16x32_bf16 v[120:123], v[188:191], v[208:211], v[120:123]
    ds_read_b128 v[144:147], v4 offset:6144
    v_mfma_f32_16x16x32_bf16 v[124:127], v[188:191], v[212:215], v[124:127]
    ds_read_b64_tr_b16 v[164:165], v8 offset:256
    v_mfma_f32_16x16x32_bf16 v[56:59], v[200:203], v[176:179], v[56:59]
    ds_read_b64_tr_b16 v[166:167], v8 offset:1792
    v_mfma_f32_16x16x32_bf16 v[60:63], v[204:207], v[176:179], v[60:63]
    ds_read_b64_tr_b16 v[168:169], v9 offset:256
    v_mfma_f32_16x16x32_bf16 v[96:99], v[176:179], v[208:211], v[96:99]
    ds_read_b64_tr_b16 v[170:171], v9 offset:1792
    v_mfma_f32_16x16x32_bf16 v[100:103], v[176:179], v[212:215], v[100:103]
    ds_read_b128 v[132:135], v4 offset:0
    v_mfma_f32_16x16x32_bf16 v[64:67], v[200:203], v[180:183], v[64:67]
    ds_read_b64_tr_b16 v[148:149], v8 offset:0
    v_mfma_f32_16x16x32_bf16 v[68:71], v[204:207], v[180:183], v[68:71]
    ds_read_b64_tr_b16 v[150:151], v8 offset:1536
    v_mfma_f32_16x16x32_bf16 v[104:107], v[180:183], v[208:211], v[104:107]
    ds_read_b128 v[136:139], v4 offset:2048
    v_mfma_f32_16x16x32_bf16 v[108:111], v[180:183], v[212:215], v[108:111]
    ds_read_b64_tr_b16 v[152:153], v9 offset:0
    v_mfma_f32_16x16x32_bf16 v[72:75], v[200:203], v[184:187], v[72:75]
    ds_read_b64_tr_b16 v[154:155], v9 offset:1536
    v_mfma_f32_16x16x32_bf16 v[76:79], v[204:207], v[184:187], v[76:79]
    ds_read_b128 v[140:143], v4 offset:4096
    v_mfma_f32_16x16x32_bf16 v[112:115], v[184:187], v[208:211], v[112:115]
    v_add_u32 v5, s54, v5
    v_add_u32 v7, v15, v7
    v_mfma_f32_16x16x32_bf16 v[116:119], v[184:187], v[212:215], v[116:119]
    v_mfma_f32_16x16x32_bf16 v[16:19], v[192:195], v[176:179], v[16:19]
    v_mfma_f32_16x16x32_bf16 v[20:23], v[196:199], v[176:179], v[20:23]
    v_mfma_f32_16x16x32_bf16 v[24:27], v[192:195], v[180:183], v[24:27]
    v_mfma_f32_16x16x32_bf16 v[28:31], v[196:199], v[180:183], v[28:31]
    v_mfma_f32_16x16x32_bf16 v[32:35], v[192:195], v[184:187], v[32:35]
    v_mfma_f32_16x16x32_bf16 v[36:39], v[196:199], v[184:187], v[36:39]
    v_mfma_f32_16x16x32_bf16 v[40:43], v[192:195], v[188:191], v[40:43]
    v_mfma_f32_16x16x32_bf16 v[44:47], v[196:199], v[188:191], v[44:47]
    s_branch L_c_loop0
L_c_last0:
    v_mfma_f32_16x16x32_bf16 v[44:47], v[152:155], v[144:147], v[44:47]
    s_waitcnt lgkmcnt(0)
    v_mfma_f32_16x16x32_bf16 v[48:51], v[200:203], v[172:175], v[48:51]
    v_lshlrev_b32 v220, 3, v2
    s_mul_i32 s57, s30, 14336
    s_add_u32 s57, s57, 133120
    v_mfma_f32_16x16x32_bf16 v[52:55], v[204:207], v[172:175], v[52:55]
    v_and_b32 v4, 1, v0
    v_lshlrev_b32 v5, 2, v2
    buffer_load_dwordx2 v[232:233], v220, s[36:39], s59 offen offset:0 sc1
    v_mfma_f32_16x16x32_bf16 v[88:91], v[192:195], v[172:175], v[88:91]
    v_lshl_add_u32 v6, v3, 2, v4
    v_lshlrev_b32 v7, 4, v3
    buffer_load_dwordx2 v[234:235], v220, s[36:39], s59 offen offset:128 sc1
    v_mfma_f32_16x16x32_bf16 v[80:83], v[200:203], v[188:191], v[80:83]
    v_cmp_le_u32 s[62:63], v6, v2
    v_add_u32 v8, 2, v6
    v_mfma_f32_16x16x32_bf16 v[84:87], v[204:207], v[188:191], v[84:87]
    v_cmp_le_u32 s[64:65], v8, v2
    v_cmp_eq_u32 s[60:61], 1, v4
    v_mfma_f32_16x16x32_bf16 v[120:123], v[188:191], v[208:211], v[120:123]
    v_lshl_add_u32 v14, v0, 4, s57
    v_add_u32 v10, s57, v7
    v_mfma_f32_16x16x32_bf16 v[124:127], v[188:191], v[212:215], v[124:127]
    v_add_u32 v11, s57, v5
    v_cndmask_b32 v9, 0, 16, s[62:63]
    v_mfma_f32_16x16x32_bf16 v[56:59], v[200:203], v[176:179], v[56:59]
    v_cndmask_b32 v15, 0, 16, s[64:65]
    s_mov_b32 s50, 0x00010001
    v_mfma_f32_16x16x32_bf16 v[60:63], v[204:207], v[176:179], v[60:63]
    s_mov_b32 s51, s50
    v_add_lshl_u32 v6, v6, v9, 2
    v_mfma_f32_16x16x32_bf16 v[96:99], v[176:179], v[208:211], v[96:99]
    v_add_lshl_u32 v8, v8, v15, 2
    v_add_u32 v9, 896, v5
    v_mfma_f32_16x16x32_bf16 v[100:103], v[176:179], v[212:215], v[100:103]
    v_add_u32 v6, 832, v6
    v_add_u32 v8, 832, v8
    v_mfma_f32_16x16x32_bf16 v[64:67], v[200:203], v[180:183], v[64:67]
    ds_write_b128 v14, v[80:83]
    ds_write_b128 v14, v[84:87] offset:1024
    v_mfma_f32_16x16x32_bf16 v[68:71], v[204:207], v[180:183], v[68:71]
    ds_write_b128 v14, v[120:123] offset:2048
    ds_write_b128 v14, v[124:127] offset:3072
    v_mfma_f32_16x16x32_bf16 v[104:107], v[180:183], v[208:211], v[104:107]
    s_mov_b64 exec, s[50:51]
    ds_write_b128 v10, v[88:91] offset:6144
    ds_write_b128 v10, v[48:51] offset:6272
    ds_write_b128 v10, v[52:55] offset:6336
    s_mov_b64 exec, -1
    v_mfma_f32_16x16x32_bf16 v[108:111], v[180:183], v[212:215], v[108:111]
    v_lshlrev_b32 v4, 4, v4
    v_mov_b32 v15, 0xffff
    v_mfma_f32_16x16x32_bf16 v[72:75], v[200:203], v[184:187], v[72:75]
    v_lshlrev_b32 v15, v4, v15
    s_lshl_b32 s48, s3, 2
    v_mfma_f32_16x16x32_bf16 v[76:79], v[204:207], v[184:187], v[76:79]
    v_cndmask_b32 v216, v15, 0, s[62:63]
    v_cndmask_b32 v217, v15, 0, s[64:65]
    v_mfma_f32_16x16x32_bf16 v[112:115], v[184:187], v[208:211], v[112:115]
    v_cndmask_b32 v218, 0, v15, s[62:63]
    v_cndmask_b32 v219, 0, v15, s[64:65]
    v_mfma_f32_16x16x32_bf16 v[116:119], v[184:187], v[212:215], v[116:119]
    s_waitcnt lgkmcnt(0)
    s_barrier
    v_mfma_f32_16x16x32_bf16 v[16:19], v[192:195], v[176:179], v[16:19]
    ds_read_b128 v[88:91], v14 offset:4096
    ds_read_b128 v[92:95], v14 offset:5120
    v_mfma_f32_16x16x32_bf16 v[20:23], v[196:199], v[176:179], v[20:23]
    ds_read2_b32 v[128:129], v5 offset0:64 offset1:80
    ds_read2_b32 v[130:131], v5 offset0:96 offset1:112
    v_mfma_f32_16x16x32_bf16 v[24:27], v[192:195], v[180:183], v[24:27]
    ds_read_b32 v132, v5 offset:512
    ds_read_b128 v[136:139], v7 offset:256
    v_mfma_f32_16x16x32_bf16 v[28:31], v[196:199], v[180:183], v[28:31]
    ds_read_b128 v[140:143], v7 offset:320
    ds_read_b128 v[144:147], v7 offset:384
    v_mfma_f32_16x16x32_bf16 v[32:35], v[192:195], v[184:187], v[32:35]
    ds_read_b128 v[148:151], v7 offset:448
    ds_read_b128 v[152:155], v7 offset:512
    v_mfma_f32_16x16x32_bf16 v[36:39], v[196:199], v[184:187], v[36:39]
    ds_read2_b32 v[156:157], v9 offset0:0 offset1:16
    ds_read2_b32 v[158:159], v9 offset0:32 offset1:48
    v_mfma_f32_16x16x32_bf16 v[40:43], v[192:195], v[188:191], v[40:43]
    ds_read2_b32 v[160:161], v6 offset0:0 offset1:16
    ds_read2_b32 v[162:163], v6 offset0:32 offset1:48
    v_mfma_f32_16x16x32_bf16 v[44:47], v[196:199], v[188:191], v[44:47]
    ds_read2_b32 v[164:165], v8 offset0:0 offset1:16
    ds_read2_b32 v[166:167], v8 offset0:32 offset1:48
    ds_read_b128 v[180:183], v10 offset:6272
    ds_read_b128 v[184:187], v10 offset:6336
    s_branch L_c_epi
L_c_loop1:
    s_waitcnt lgkmcnt(0)
    v_mfma_f32_16x16x32_bf16 v[48:51], v[128:131], v[164:167], v[48:51]
    ds_read_b128 v[172:175], v7
    s_add_u32 s52, s52, 1
    v_mfma_f32_16x16x32_bf16 v[52:55], v[128:131], v[168:171], v[52:55]
    ds_read_b64_tr_b16 v[200:201], v8 offset:12416
    s_cmp_eq_u32 s52, 3
    v_mfma_f32_16x16x32_bf16 v[88:91], v[152:155], v[128:131], v[88:91]
    ds_read_b64_tr_b16 v[202:203], v8 offset:13952
    s_cselect_b32 s52, 0, s52
    v_mfma_f32_16x16x32_bf16 v[80:83], v[156:159], v[144:147], v[80:83]
    ds_read_b64_tr_b16 v[204:205], v9 offset:12416
    s_cselect_b32 s54, 4294881280, s55
    v_mfma_f32_16x16x32_bf16 v[84:87], v[160:163], v[144:147], v[84:87]
    ds_read_b64_tr_b16 v[206:207], v9 offset:13952
    s_add_u32 s53, s53, 1
    v_mfma_f32_16x16x32_bf16 v[120:123], v[144:147], v[164:167], v[120:123]
    ds_read_b128 v[188:191], v5 offset:6144
    v_mfma_f32_16x16x32_bf16 v[124:127], v[144:147], v[168:171], v[124:127]
    ds_read_b64_tr_b16 v[208:209], v8 offset:12544
    v_mfma_f32_16x16x32_bf16 v[56:59], v[156:159], v[132:135], v[56:59]
    ds_read_b64_tr_b16 v[210:211], v8 offset:14080
    v_mfma_f32_16x16x32_bf16 v[60:63], v[160:163], v[132:135], v[60:63]
    ds_read_b64_tr_b16 v[212:213], v9 offset:12544
    v_mfma_f32_16x16x32_bf16 v[96:99], v[132:135], v[164:167], v[96:99]
    ds_read_b64_tr_b16 v[214:215], v9 offset:14080
    v_mfma_f32_16x16x32_bf16 v[100:103], v[132:135], v[168:171], v[100:103]
    ds_read_b128 v[176:179], v5 offset:0
    v_mfma_f32_16x16x32_bf16 v[64:67], v[156:159], v[136:139], v[64:67]
    ds_read_b64_tr_b16 v[192:193], v8 offset:12288
    v_mfma_f32_16x16x32_bf16 v[68:71], v[160:163], v[136:139], v[68:71]
    ds_read_b64_tr_b16 v[194:195], v8 offset:13824
    v_mfma_f32_16x16x32_bf16 v[104:107], v[136:139], v[164:167], v[104:107]
    ds_read_b128 v[180:183], v5 offset:2048
    v_mfma_f32_16x16x32_bf16 v[108:111], v[136:139], v[168:171], v[108:111]
    ds_read_b64_tr_b16 v[196:197], v9 offset:12288
    v_mfma_f32_16x16x32_bf16 v[72:75], v[156:159], v[140:143], v[72:75]
    ds_read_b64_tr_b16 v[198:199], v9 offset:13824
    v_mfma_f32_16x16x32_bf16 v[76:79], v[160:163], v[140:143], v[76:79]
    ds_read_b128 v[184:187], v5 offset:4096
    v_mfma_f32_16x16x32_bf16 v[112:115], v[140:143], v[164:167], v[112:115]
    v_add_u32 v8, s54, v8
    v_add_u32 v9, s54, v9
    v_mfma_f32_16x16x32_bf16 v[116:119], v[140:143], v[168:171], v[116:119]
    v_and_b32 v15, s54, v10
    v_add_u32 v4, s54, v4
    v_mfma_f32_16x16x32_bf16 v[16:19], v[148:151], v[132:135], v[16:19]
    v_add_u32 v6, v15, v6
    s_cmp_eq_u32 s53, 16
    v_mfma_f32_16x16x32_bf16 v[20:23], v[152:155], v[132:135], v[20:23]
    v_mfma_f32_16x16x32_bf16 v[24:27], v[148:151], v[136:139], v[24:27]
    v_mfma_f32_16x16x32_bf16 v[28:31], v[152:155], v[136:139], v[28:31]
    v_mfma_f32_16x16x32_bf16 v[32:35], v[148:151], v[140:143], v[32:35]
    v_mfma_f32_16x16x32_bf16 v[36:39], v[152:155], v[140:143], v[36:39]
    v_mfma_f32_16x16x32_bf16 v[40:43], v[148:151], v[144:147], v[40:43]
    s_cbranch_scc1 L_c_last1
    s_waitcnt lgkmcnt(0)
    s_barrier
    v_mfma_f32_16x16x32_bf16 v[44:47], v[152:155], v[144:147], v[44:47]
    v_mfma_f32_16x16x32_bf16 v[48:51], v[172:175], v[208:211], v[48:51]
    ds_read_b128 v[128:131], v6
    v_mfma_f32_16x16x32_bf16 v[52:55], v[172:175], v[212:215], v[52:55]
    ds_read_b64_tr_b16 v[156:157], v8 offset:128
    v_mfma_f32_16x16x32_bf16 v[88:91], v[196:199], v[172:175], v[88:91]
    ds_read_b64_tr_b16 v[158:159], v8 offset:1664
    v_mfma_f32_16x16x32_bf16 v[80:83], v[200:203], v[188:191], v[80:83]
    ds_read_b64_tr_b16 v[160:161], v9 offset:128
    v_mfma_f32_16x16x32_bf16 v[84:87], v[204:207], v[188:191], v[84:87]
    ds_read_b64_tr_b16 v[162:163], v9 offset:1664
    v_mfma_f32_16x16x32_bf16 v[120:123], v[188:191], v[208:211], v[120:123]
    ds_read_b128 v[144:147], v4 offset:6144
    v_mfma_f32_16x16x32_bf16 v[124:127], v[188:191], v[212:215], v[124:127]
    ds_read_b64_tr_b16 v[164:165], v8 offset:256
    v_mfma_f32_16x16x32_bf16 v[56:59], v[200:203], v[176:179], v[56:59]
    ds_read_b64_tr_b16 v[166:167], v8 offset:1792
    v_mfma_f32_16x16x32_bf16 v[60:63], v[204:207], v[176:179], v[60:63]
    ds_read_b64_tr_b16 v[168:169], v9 offset:256
    v_mfma_f32_16x16x32_bf16 v[96:99], v[176:179], v[208:211], v[96:99]
    ds_read_b64_tr_b16 v[170:171], v9 offset:1792
    v_mfma_f32_16x16x32_bf16 v[100:103], v[176:179], v[212:215], v[100:103]
    ds_read_b128 v[132:135], v4 offset:0
    v_mfma_f32_16x16x32_bf16 v[64:67], v[200:203], v[180:183], v[64:67]
    ds_read_b64_tr_b16 v[148:149], v8 offset:0
    v_mfma_f32_16x16x32_bf16 v[68:71], v[204:207], v[180:183], v[68:71]
    ds_read_b64_tr_b16 v[150:151], v8 offset:1536
    v_mfma_f32_16x16x32_bf16 v[104:107], v[180:183], v[208:211], v[104:107]
    ds_read_b128 v[136:139], v4 offset:2048
    v_mfma_f32_16x16x32_bf16 v[108:111], v[180:183], v[212:215], v[108:111]
    ds_read_b64_tr_b16 v[152:153], v9 offset:0
    v_mfma_f32_16x16x32_bf16 v[72:75], v[200:203], v[184:187], v[72:75]
    ds_read_b64_tr_b16 v[154:155], v9 offset:1536
    v_mfma_f32_16x16x32_bf16 v[76:79], v[204:207], v[184:187], v[76:79]
    ds_read_b128 v[140:143], v4 offset:4096
    v_mfma_f32_16x16x32_bf16 v[112:115], v[184:187], v[208:211], v[112:115]
    v_add_u32 v5, s54, v5
    v_add_u32 v7, v15, v7
    v_mfma_f32_16x16x32_bf16 v[116:119], v[184:187], v[212:215], v[116:119]
    v_mfma_f32_16x16x32_bf16 v[16:19], v[192:195], v[176:179], v[16:19]
    v_mfma_f32_16x16x32_bf16 v[20:23], v[196:199], v[176:179], v[20:23]
    v_mfma_f32_16x16x32_bf16 v[24:27], v[192:195], v[180:183], v[24:27]
    v_mfma_f32_16x16x32_bf16 v[28:31], v[196:199], v[180:183], v[28:31]
    v_mfma_f32_16x16x32_bf16 v[32:35], v[192:195], v[184:187], v[32:35]
    v_mfma_f32_16x16x32_bf16 v[36:39], v[196:199], v[184:187], v[36:39]
    v_mfma_f32_16x16x32_bf16 v[40:43], v[192:195], v[188:191], v[40:43]
    v_mfma_f32_16x16x32_bf16 v[44:47], v[196:199], v[188:191], v[44:47]
    s_branch L_c_loop1
L_c_last1:
    v_mfma_f32_16x16x32_bf16 v[44:47], v[152:155], v[144:147], v[44:47]
    s_waitcnt lgkmcnt(0)
    v_mfma_f32_16x16x32_bf16 v[48:51], v[172:175], v[208:211], v[48:51]
    v_lshlrev_b32 v220, 3, v2
    s_mul_i32 s57, s30, 14336
    s_add_u32 s57, s57, 133120
    v_mfma_f32_16x16x32_bf16 v[52:55], v[172:175], v[212:215], v[52:55]
    v_and_b32 v4, 1, v0
    v_lshlrev_b32 v5, 2, v2
    buffer_load_dwordx2 v[232:233], v220, s[36:39], s59 offen offset:0 sc1
    v_mfma_f32_16x16x32_bf16 v[88:91], v[196:199], v[172:175], v[88:91]
    v_lshl_add_u32 v6, v3, 2, v4
    v_lshlrev_b32 v7, 4, v3
    buffer_load_dwordx2 v[234:235], v220, s[36:39], s59 offen offset:128 sc1
    v_mfma_f32_16x16x32_bf16 v[80:83], v[200:203], v[188:191], v[80:83]
    v_cmp_le_u32 s[62:63], v6, v2
    v_add_u32 v8, 2, v6
    v_mfma_f32_16x16x32_bf16 v[84:87], v[204:207], v[188:191], v[84:87]
    v_cmp_le_u32 s[64:65], v8, v2
    v_cmp_eq_u32 s[60:61], 1, v4
    v_mfma_f32_16x16x32_bf16 v[120:123], v[188:191], v[208:211], v[120:123]
    v_lshl_add_u32 v14, v0, 4, s57
    v_add_u32 v10, s57, v7
    v_mfma_f32_16x16x32_bf16 v[124:127], v[188:191], v[212:215], v[124:127]
    v_add_u32 v11, s57, v5
    v_cndmask_b32 v9, 0, 16, s[62:63]
    v_mfma_f32_16x16x32_bf16 v[56:59], v[200:203], v[176:179], v[56:59]
    v_cndmask_b32 v15, 0, 16, s[64:65]
    s_mov_b32 s50, 0x00010001
    v_mfma_f32_16x16x32_bf16 v[60:63], v[204:207], v[176:179], v[60:63]
    s_mov_b32 s51, s50
    v_add_lshl_u32 v6, v6, v9, 2
    v_mfma_f32_16x16x32_bf16 v[96:99], v[176:179], v[208:211], v[96:99]
    v_add_lshl_u32 v8, v8, v15, 2
    v_add_u32 v9, 1152, v5
    v_mfma_f32_16x16x32_bf16 v[100:103], v[176:179], v[212:215], v[100:103]
    v_add_u32 v6, 1088, v6
    v_add_u32 v8, 1088, v8
    v_mfma_f32_16x16x32_bf16 v[64:67], v[200:203], v[180:183], v[64:67]
    ds_write_b128 v14, v[48:51] offset:4096
    ds_write_b128 v14, v[52:55] offset:5120
    v_mfma_f32_16x16x32_bf16 v[68:71], v[204:207], v[180:183], v[68:71]
    s_mov_b64 exec, s[50:51]
    ds_write_b128 v10, v[88:91] offset:6208
    s_mov_b64 exec, -1
    v_mfma_f32_16x16x32_bf16 v[104:107], v[180:183], v[208:211], v[104:107]
    s_mov_b64 exec, 0xffff
    ds_write_b32 v11, v48 offset:6400
    ds_write_b32 v11, v52 offset:6464
    s_mov_b64 exec, -1
    v_mfma_f32_16x16x32_bf16 v[108:111], v[180:183], v[212:215], v[108:111]
    v_lshlrev_b32 v4, 4, v4
    v_mov_b32 v15, 0xffff
    v_mfma_f32_16x16x32_bf16 v[72:75], v[200:203], v[184:187], v[72:75]
    v_lshlrev_b32_e64 v15, v4, v15
    s_lshl_b32 s48, s3, 2
    v_mfma_f32_16x16x32_bf16 v[76:79], v[204:207], v[184:187], v[76:79]
    v_cndmask_b32 v216, v15, 0, s[62:63]
    v_cndmask_b32 v217, v15, 0, s[64:65]
    v_mfma_f32_16x16x32_bf16 v[112:115], v[184:187], v[208:211], v[112:115]
    v_cndmask_b32 v218, 0, v15, s[62:63]
    v_cndmask_b32 v219, 0, v15, s[64:65]
    v_mfma_f32_16x16x32_bf16 v[116:119], v[184:187], v[212:215], v[116:119]
    s_waitcnt lgkmcnt(0)
    s_barrier
    v_mfma_f32_16x16x32_bf16 v[16:19], v[192:195], v[176:179], v[16:19]
    ds_read_b128 v[48:51], v14 offset:0
    ds_read_b128 v[52:55], v14 offset:1024
    v_mfma_f32_16x16x32_bf16 v[20:23], v[196:199], v[176:179], v[20:23]
    ds_read_b128 v[88:91], v14 offset:2048
    ds_read_b128 v[92:95], v14 offset:3072
    v_mfma_f32_16x16x32_bf16 v[24:27], v[192:195], v[180:183], v[24:27]
    ds_read2_b32 v[128:129], v5 offset0:128 offset1:144
    ds_read2_b32 v[130:131], v5 offset0:160 offset1:176
    v_mfma_f32_16x16x32_bf16 v[28:31], v[196:199], v[180:183], v[28:31]
    ds_read_b32 v132, v5 offset:768
    ds_read_b128 v[136:139], v7 offset:512
    v_mfma_f32_16x16x32_bf16 v[32:35], v[192:195], v[184:187], v[32:35]
    ds_read_b128 v[140:143], v7 offset:576
    ds_read_b128 v[144:147], v7 offset:640
    v_mfma_f32_16x16x32_bf16 v[36:39], v[196:199], v[184:187], v[36:39]
    ds_read_b128 v[148:151], v7 offset:704
    ds_read_b128 v[152:155], v7 offset:768
    v_mfma_f32_16x16x32_bf16 v[40:43], v[192:195], v[188:191], v[40:43]
    ds_read2_b32 v[156:157], v9 offset0:0 offset1:16
    ds_read2_b32 v[158:159], v9 offset0:32 offset1:48
    v_mfma_f32_16x16x32_bf16 v[44:47], v[196:199], v[188:191], v[44:47]
    ds_read2_b32 v[160:161], v6 offset0:0 offset1:16
    ds_read2_b32 v[162:163], v6 offset0:32 offset1:48
    ds_read_b128 v[180:183], v10 offset:6272
    ds_read_b128 v[184:187], v10 offset:6336
    ds_read2_b32 v[164:165], v8 offset0:0 offset1:16
    ds_read2_b32 v[166:167], v8 offset0:32 offset1:48
L_c_epi:
    ds_read_b128 v[172:175], v10 offset:6144
    ds_read_b128 v[176:179], v10 offset:6208
    ds_read_b32 v188, v11 offset:6400
    ds_read_b32 v189, v11 offset:6464
    s_mul_i32 s28, s28, 0x9E3779B1
    s_add_u32 s28, s28, 0x7F4A7C15
    s_mov_b32 s66, 0x3e8293ee
    s_mov_b32 s67, s66
    v_mov_b32 v4, s48
    v_mov_b32 v15, 1
    s_waitcnt lgkmcnt(4)
    v_pk_fma_f32 v[48:49], v[128:129], v[180:181], v[48:49] op_sel:[0,0,0] op_sel_hi:[0,1,1] neg_lo:[1,0,0] neg_hi:[1,0,0]
    v_pk_fma_f32 v[50:51], v[128:129], v[182:183], v[50:51] op_sel:[0,0,0] op_sel_hi:[0,1,1] neg_lo:[1,0,0] neg_hi:[1,0,0]
    v_pk_fma_f32 v[52:53], v[128:129], v[184:185], v[52:53] op_sel:[0,0,0] op_sel_hi:[0,1,1] neg_lo:[1,0,0] neg_hi:[1,0,0]
    v_pk_fma_f32 v[54:55], v[128:129], v[186:187], v[54:55] op_sel:[0,0,0] op_sel_hi:[0,1,1] neg_lo:[1,0,0] neg_hi:[1,0,0]
    v_pk_fma_f32 v[56:57], v[128:129], v[180:181], v[56:57] op_sel:[1,0,0] op_sel_hi:[1,1,1] neg_lo:[1,0,0] neg_hi:[1,0,0]
    v_pk_fma_f32 v[58:59], v[128:129], v[182:183], v[58:59] op_sel:[1,0,0] op_sel_hi:[1,1,1] neg_lo:[1,0,0] neg_hi:[1,0,0]
    v_pk_fma_f32 v[60:61], v[128:129], v[184:185], v[60:61] op_sel:[1,0,0] op_sel_hi:[1,1,1] neg_lo:[1,0,0] neg_hi:[1,0,0]
    v_pk_fma_f32 v[62:63], v[128:129], v[186:187], v[62:63] op_sel:[1,0,0] op_sel_hi:[1,1,1] neg_lo:[1,0,0] neg_hi:[1,0,0]
    v_pk_fma_f32 v[64:65], v[130:131], v[180:181], v[64:65] op_sel:[0,0,0] op_sel_hi:[0,1,1] neg_lo:[1,0,0] neg_hi:[1,0,0]
    v_pk_fma_f32 v[66:67], v[130:131], v[182:183], v[66:67] op_sel:[0,0,0] op_sel_hi:[0,1,1] neg_lo:[1,0,0] neg_hi:[1,0,0]
    v_pk_fma_f32 v[68:69], v[130:131], v[184:185], v[68:69] op_sel:[0,0,0] op_sel_hi:[0,1,1] neg_lo:[1,0,0] neg_hi:[1,0,0]
    v_pk_fma_f32 v[70:71], v[130:131], v[186:187], v[70:71] op_sel:[0,0,0] op_sel_hi:[0,1,1] neg_lo:[1,0,0] neg_hi:[1,0,0]
    v_pk_fma_f32 v[72:73], v[130:131], v[180:181], v[72:73] op_sel:[1,0,0] op_sel_hi:[1,1,1] neg_lo:[1,0,0] neg_hi:[1,0,0]
    v_pk_fma_f32 v[74:75], v[130:131], v[182:183], v[74:75] op_sel:[1,0,0] op_sel_hi:[1,1,1] neg_lo:[1,0,0] neg_hi:[1,0,0]
    v_pk_fma_f32 v[76:77], v[130:131], v[184:185], v[76:77] op_sel:[1,0,0] op_sel_hi:[1,1,1] neg_lo:[1,0,0] neg_hi:[1,0,0]
    v_pk_fma_f32 v[78:79], v[130:131], v[186:187], v[78:79] op_sel:[1,0,0] op_sel_hi:[1,1,1] neg_lo:[1,0,0] neg_hi:[1,0,0]
    v_pk_fma_f32 v[80:81], v[132:133], v[180:181], v[80:81] op_sel:[0,0,0] op_sel_hi:[0,1,1] neg_lo:[1,0,0] neg_hi:[1,0,0]
    v_pk_fma_f32 v[82:83], v[132:133], v[182:183], v[82:83] op_sel:[0,0,0] op_sel_hi:[0,1,1] neg_lo:[1,0,0] neg_hi:[1,0,0]
    v_pk_fma_f32 v[84:85], v[132:133], v[184:185], v[84:85] op_sel:[0,0,0] op_sel_hi:[0,1,1] neg_lo:[1,0,0] neg_hi:[1,0,0]
    v_pk_fma_f32 v[86:87], v[132:133], v[186:187], v[86:87] op_sel:[0,0,0] op_sel_hi:[0,1,1] neg_lo:[1,0,0] neg_hi:[1,0,0]
    v_pk_mul_f32 v[156:157], v[156:157], s[66:67]
    v_pk_mul_f32 v[158:159], v[158:159], s[66:67]
    s_waitcnt lgkmcnt(0)
    s_mov_b64 exec, 1
    ds_write_b32 v4, v15 offset:160
    s_mov_b64 exec, -1
    s_nop 0
    v_pk_fma_f32 v[16:17], v[128:129], v[172:173], v[16:17] op_sel:[1,0,0] op_sel_hi:[1,1,1] neg_lo:[1,0,0] neg_hi:[1,0,0]
    v_pk_fma_f32 v[18:19], v[128:129], v[174:175], v[18:19] op_sel:[1,0,0] op_sel_hi:[1,1,1] neg_lo:[1,0,0] neg_hi:[1,0,0]
    v_pk_fma_f32 v[20:21], v[128:129], v[176:177], v[20:21] op_sel:[1,0,0] op_sel_hi:[1,1,1] neg_lo:[1,0,0] neg_hi:[1,0,0]
    v_pk_fma_f32 v[22:23], v[128:129], v[178:179], v[22:23] op_sel:[1,0,0] op_sel_hi:[1,1,1] neg_lo:[1,0,0] neg_hi:[1,0,0]
    v_pk_fma_f32 v[24:25], v[130:131], v[172:173], v[24:25] op_sel:[0,0,0] op_sel_hi:[0,1,1] neg_lo:[1,0,0] neg_hi:[1,0,0]
    v_pk_fma_f32 v[26:27], v[130:131], v[174:175], v[26:27] op_sel:[0,0,0] op_sel_hi:[0,1,1] neg_lo:[1,0,0] neg_hi:[1,0,0]
    v_pk_fma_f32 v[28:29], v[130:131], v[176:177], v[28:29] op_sel:[0,0,0] op_sel_hi:[0,1,1] neg_lo:[1,0,0] neg_hi:[1,0,0]
    v_pk_fma_f32 v[30:31], v[130:131], v[178:179], v[30:31] op_sel:[0,0,0] op_sel_hi:[0,1,1] neg_lo:[1,0,0] neg_hi:[1,0,0]
    v_pk_fma_f32 v[32:33], v[130:131], v[172:173], v[32:33] op_sel:[1,0,0] op_sel_hi:[1,1,1] neg_lo:[1,0,0] neg_hi:[1,0,0]
    v_pk_fma_f32 v[34:35], v[130:131], v[174:175], v[34:35] op_sel:[1,0,0] op_sel_hi:[1,1,1] neg_lo:[1,0,0] neg_hi:[1,0,0]
    v_pk_fma_f32 v[36:37], v[130:131], v[176:177], v[36:37] op_sel:[1,0,0] op_sel_hi:[1,1,1] neg_lo:[1,0,0] neg_hi:[1,0,0]
    v_pk_fma_f32 v[38:39], v[130:131], v[178:179], v[38:39] op_sel:[1,0,0] op_sel_hi:[1,1,1] neg_lo:[1,0,0] neg_hi:[1,0,0]
    v_pk_fma_f32 v[40:41], v[132:133], v[172:173], v[40:41] op_sel:[0,0,0] op_sel_hi:[0,1,1] neg_lo:[1,0,0] neg_hi:[1,0,0]
    v_pk_fma_f32 v[42:43], v[132:133], v[174:175], v[42:43] op_sel:[0,0,0] op_sel_hi:[0,1,1] neg_lo:[1,0,0] neg_hi:[1,0,0]
    v_pk_fma_f32 v[44:45], v[132:133], v[176:177], v[44:45] op_sel:[0,0,0] op_sel_hi:[0,1,1] neg_lo:[1,0,0] neg_hi:[1,0,0]
    v_pk_fma_f32 v[46:47], v[132:133], v[178:179], v[46:47] op_sel:[0,0,0] op_sel_hi:[0,1,1] neg_lo:[1,0,0] neg_hi:[1,0,0]
    v_pk_fma_f32 v[88:89], v[188:189], v[136:137], v[88:89] op_sel:[0,0,0] op_sel_hi:[0,1,1] neg_lo:[1,0,0] neg_hi:[1,0,0]
    v_pk_fma_f32 v[90:91], v[188:189], v[138:139], v[90:91] op_sel:[0,0,0] op_sel_hi:[0,1,1] neg_lo:[1,0,0] neg_hi:[1,0,0]
    v_pk_fma_f32 v[92:93], v[188:189], v[136:137], v[92:93] op_sel:[1,0,0] op_sel_hi:[1,1,1] neg_lo:[1,0,0] neg_hi:[1,0,0]
    v_pk_fma_f32 v[94:95], v[188:189], v[138:139], v[94:95] op_sel:[1,0,0] op_sel_hi:[1,1,1] neg_lo:[1,0,0] neg_hi:[1,0,0]
    v_pk_fma_f32 v[96:97], v[188:189], v[140:141], v[96:97] op_sel:[0,0,0] op_sel_hi:[0,1,1] neg_lo:[1,0,0] neg_hi:[1,0,0]
    v_pk_fma_f32 v[98:99], v[188:189], v[142:143], v[98:99] op_sel:[0,0,0] op_sel_hi:[0,1,1] neg_lo:[1,0,0] neg_hi:[1,0,0]
    v_pk_fma_f32 v[100:101], v[188:189], v[140:141], v[100:101] op_sel:[1,0,0] op_sel_hi:[1,1,1] neg_lo:[1,0,0] neg_hi:[1,0,0]
    v_pk_fma_f32 v[102:103], v[188:189], v[142:143], v[102:103] op_sel:[1,0,0] op_sel_hi:[1,1,1] neg_lo:[1,0,0] neg_hi:[1,0,0]
    v_pk_fma_f32 v[104:105], v[188:189], v[144:145], v[104:105] op_sel:[0,0,0] op_sel_hi:[0,1,1] neg_lo:[1,0,0] neg_hi:[1,0,0]
    v_pk_fma_f32 v[106:107], v[188:189], v[146:147], v[106:107] op_sel:[0,0,0] op_sel_hi:[0,1,1] neg_lo:[1,0,0] neg_hi:[1,0,0]
    v_pk_fma_f32 v[108:109], v[188:189], v[144:145], v[108:109] op_sel:[1,0,0] op_sel_hi:[1,1,1] neg_lo:[1,0,0] neg_hi:[1,0,0]
    v_pk_fma_f32 v[110:111], v[188:189], v[146:147], v[110:111] op_sel:[1,0,0] op_sel_hi:[1,1,1] neg_lo:[1,0,0] neg_hi:[1,0,0]
    v_pk_fma_f32 v[112:113], v[188:189], v[148:149], v[112:113] op_sel:[0,0,0] op_sel_hi:[0,1,1] neg_lo:[1,0,0] neg_hi:[1,0,0]
    v_pk_fma_f32 v[114:115], v[188:189], v[150:151], v[114:115] op_sel:[0,0,0] op_sel_hi:[0,1,1] neg_lo:[1,0,0] neg_hi:[1,0,0]
    v_pk_fma_f32 v[116:117], v[188:189], v[148:149], v[116:117] op_sel:[1,0,0] op_sel_hi:[1,1,1] neg_lo:[1,0,0] neg_hi:[1,0,0]
    v_pk_fma_f32 v[118:119], v[188:189], v[150:151], v[118:119] op_sel:[1,0,0] op_sel_hi:[1,1,1] neg_lo:[1,0,0] neg_hi:[1,0,0]
    v_pk_fma_f32 v[120:121], v[188:189], v[152:153], v[120:121] op_sel:[0,0,0] op_sel_hi:[0,1,1] neg_lo:[1,0,0] neg_hi:[1,0,0]
    v_pk_fma_f32 v[122:123], v[188:189], v[154:155], v[122:123] op_sel:[0,0,0] op_sel_hi:[0,1,1] neg_lo:[1,0,0] neg_hi:[1,0,0]
    v_pk_fma_f32 v[124:125], v[188:189], v[152:153], v[124:125] op_sel:[1,0,0] op_sel_hi:[1,1,1] neg_lo:[1,0,0] neg_hi:[1,0,0]
    v_pk_fma_f32 v[126:127], v[188:189], v[154:155], v[126:127] op_sel:[1,0,0] op_sel_hi:[1,1,1] neg_lo:[1,0,0] neg_hi:[1,0,0]
    v_cvt_pk_bf16_f32 v236, v48, v49
    v_cvt_pk_bf16_f32 v237, v50, v51
    v_cvt_pk_bf16_f32 v238, v52, v53
    v_cvt_pk_bf16_f32 v239, v54, v55
    v_cvt_pk_bf16_f32 v16, v16, v17
    v_cvt_pk_bf16_f32 v17, v18, v19
    v_cvt_pk_bf16_f32 v18, v20, v21
    v_cvt_pk_bf16_f32 v19, v22, v23
    v_cvt_pk_bf16_f32 v240, v56, v57
    v_cvt_pk_bf16_f32 v241, v58, v59
    v_cvt_pk_bf16_f32 v242, v60, v61
    v_cvt_pk_bf16_f32 v243, v62, v63
    v_cvt_pk_bf16_f32 v24, v24, v25
    v_cvt_pk_bf16_f32 v25, v26, v27
    v_mfma_f32_16x16x32_bf16 v[48:51], v[240:243], v[16:19], 0
    v_cvt_pk_bf16_f32 v26, v28, v29
    v_cvt_pk_bf16_f32 v27, v30, v31
    v_cvt_pk_bf16_f32 v244, v64, v65
    v_cvt_pk_bf16_f32 v245, v66, v67
    v_mfma_f32_16x16x32_bf16 v[52:55], v[236:239], v[16:19], 0
    v_cvt_pk_bf16_f32 v246, v68, v69
    v_cvt_pk_bf16_f32 v247, v70, v71
    v_cvt_pk_bf16_f32 v32, v32, v33
    v_cvt_pk_bf16_f32 v33, v34, v35
    v_mfma_f32_16x16x32_bf16 v[56:59], v[244:247], v[24:27], 0
    v_cvt_pk_bf16_f32 v34, v36, v37
    v_cvt_pk_bf16_f32 v35, v38, v39
    v_cvt_pk_bf16_f32 v248, v72, v73
    v_cvt_pk_bf16_f32 v249, v74, v75
    v_mfma_f32_16x16x32_bf16 v[60:63], v[240:243], v[24:27], 0
    v_cvt_pk_bf16_f32 v250, v76, v77
    v_cvt_pk_bf16_f32 v251, v78, v79
    v_cvt_pk_bf16_f32 v40, v40, v41
    v_cvt_pk_bf16_f32 v41, v42, v43
    v_mfma_f32_16x16x32_bf16 v[64:67], v[248:251], v[32:35], 0
    v_cvt_pk_bf16_f32 v42, v44, v45
    v_cvt_pk_bf16_f32 v43, v46, v47
    v_cvt_pk_bf16_f32 v252, v80, v81
    v_cvt_pk_bf16_f32 v253, v82, v83
    v_mfma_f32_16x16x32_bf16 v[68:71], v[244:247], v[32:35], 0
    v_cvt_pk_bf16_f32 v254, v84, v85
    v_cvt_pk_bf16_f32 v255, v86, v87
    v_cvt_pk_bf16_f32 v192, v88, v89
    v_cvt_pk_bf16_f32 v193, v90, v91
    v_mfma_f32_16x16x32_bf16 v[72:75], v[252:255], v[40:43], 0
    v_cvt_pk_bf16_f32 v202, v92, v93
    v_cvt_pk_bf16_f32 v203, v94, v95
    v_cvt_pk_bf16_f32 v194, v96, v97
    v_cvt_pk_bf16_f32 v195, v98, v99
    v_mfma_f32_16x16x32_bf16 v[76:79], v[248:251], v[40:43], 0
    v_cvt_pk_bf16_f32 v204, v100, v101
    v_cvt_pk_bf16_f32 v205, v102, v103
    v_cvt_pk_bf16_f32 v196, v104, v105
    v_cvt_pk_bf16_f32 v197, v106, v107
    v_cvt_pk_bf16_f32 v206, v108, v109
    v_cvt_pk_bf16_f32 v207, v110, v111
    v_cvt_pk_bf16_f32 v198, v112, v113
    v_cvt_pk_bf16_f32 v199, v114, v115
    v_cvt_pk_bf16_f32 v208, v116, v117
    v_cvt_pk_bf16_f32 v209, v118, v119
    v_cvt_pk_bf16_f32 v200, v120, v121
    v_cvt_pk_bf16_f32 v201, v122, v123
    v_cvt_pk_bf16_f32 v210, v124, v125
    v_cvt_pk_bf16_f32 v211, v126, v127
    v_cndmask_b32 v20, v48, v49, s[60:61]
    v_cndmask_b32 v21, v50, v51, s[60:61]
    v_cndmask_b32 v22, v52, v53, s[60:61]
    v_cndmask_b32 v23, v54, v55, s[60:61]
    v_cndmask_b32 v28, v56, v57, s[60:61]
    v_cndmask_b32 v29, v58, v59, s[60:61]
    v_cndmask_b32 v30, v60, v61, s[60:61]
    v_cndmask_b32 v31, v62, v63, s[60:61]
    v_cndmask_b32 v36, v64, v65, s[60:61]
    v_cndmask_b32 v37, v66, v67, s[60:61]
    v_cndmask_b32 v38, v68, v69, s[60:61]
    v_cndmask_b32 v39, v70, v71, s[60:61]
    v_cndmask_b32 v44, v72, v73, s[60:61]
    v_cndmask_b32 v45, v74, v75, s[60:61]
    v_cndmask_b32 v46, v76, v77, s[60:61]
    v_cndmask_b32 v47, v78, v79, s[60:61]
    v_cndmask_b32 v20, v22, v20, s[62:63]
    v_cndmask_b32 v21, v23, v21, s[64:65]
    v_cndmask_b32 v28, v30, v28, s[62:63]
    v_cndmask_b32 v29, v31, v29, s[64:65]
    v_cndmask_b32 v36, v38, v36, s[62:63]
    v_cndmask_b32 v37, v39, v37, s[64:65]
    v_cndmask_b32 v44, v46, v44, s[62:63]
    v_cndmask_b32 v45, v47, v45, s[64:65]
    v_mul_f32 v20, v20, v160
    v_mul_f32 v21, v21, v164
    v_mul_f32 v28, v28, v161
    v_mul_f32 v29, v29, v165
    v_mul_f32 v36, v36, v162
    v_mul_f32 v37, v37, v166
    v_mul_f32 v44, v44, v163
    v_mul_f32 v45, v45, v167
    v_pk_mul_f32 v[20:21], v[156:157], v[20:21] op_sel:[0,0] op_sel_hi:[0,1]
    v_pk_mul_f32 v[28:29], v[156:157], v[28:29] op_sel:[1,0] op_sel_hi:[1,1]
    v_pk_mul_f32 v[36:37], v[158:159], v[36:37] op_sel:[0,0] op_sel_hi:[0,1]
    v_pk_mul_f32 v[44:45], v[158:159], v[44:45] op_sel:[1,0] op_sel_hi:[1,1]
    s_or_b32 s48, s24, s31
    s_cbranch_scc1 L_c_nomask
    v_mov_b32 v5, 0xce6e6b28
    v_cndmask_b32 v20, v5, v20, s[62:63]
    v_cndmask_b32 v21, v5, v21, s[64:65]
L_c_nomask:
    v_max_f32 v22, v20, v21
    v_max_f32 v23, v20, v21
    v_max_f32 v30, v28, v29
    v_max_f32 v31, v28, v29
    v_max_f32 v38, v36, v37
    v_max_f32 v39, v36, v37
    v_max_f32 v46, v44, v45
    v_max_f32 v47, v44, v45
    v_permlane16_swap_b32 v23, v22
    v_permlane16_swap_b32 v31, v30
    v_permlane16_swap_b32 v39, v38
    v_permlane16_swap_b32 v47, v46
    v_max_f32 v22, v22, v23
    v_max_f32 v30, v30, v31
    v_max_f32 v38, v38, v39
    v_max_f32 v46, v46, v47
    v_mov_b32 v23, v22
    v_mov_b32 v31, v30
    v_mov_b32 v39, v38
    v_mov_b32 v47, v46
    v_permlane32_swap_b32 v23, v22
    v_permlane32_swap_b32 v31, v30
    v_permlane32_swap_b32 v39, v38
    v_permlane32_swap_b32 v47, v46
    v_max_f32 v22, v22, v23
    v_max_f32 v30, v30, v31
    v_max_f32 v38, v38, v39
    v_max_f32 v46, v46, v47
    v_pk_add_f32 v[20:21], v[20:21], v[22:23] op_sel_hi:[1,0] neg_lo:[0,1] neg_hi:[0,1]
    v_pk_add_f32 v[28:29], v[28:29], v[30:31] op_sel_hi:[1,0] neg_lo:[0,1] neg_hi:[0,1]
    v_pk_add_f32 v[36:37], v[36:37], v[38:39] op_sel_hi:[1,0] neg_lo:[0,1] neg_hi:[0,1]
    v_pk_add_f32 v[44:45], v[44:45], v[46:47] op_sel_hi:[1,0] neg_lo:[0,1] neg_hi:[0,1]
    v_exp_f32 v20, v20
    v_exp_f32 v21, v21
    v_exp_f32 v28, v28
    v_exp_f32 v29, v29
    v_exp_f32 v36, v36
    v_exp_f32 v37, v37
    v_exp_f32 v44, v44
    v_exp_f32 v45, v45
    v_add_f32 v22, v20, v21
    v_add_f32 v23, v20, v21
    v_add_f32 v30, v28, v29
    v_add_f32 v31, v28, v29
    v_add_f32 v38, v36, v37
    v_add_f32 v39, v36, v37
    v_add_f32 v46, v44, v45
    v_add_f32 v47, v44, v45
    v_permlane16_swap_b32 v23, v22
    v_permlane16_swap_b32 v31, v30
    v_permlane16_swap_b32 v39, v38
    v_permlane16_swap_b32 v47, v46
    v_add_f32 v22, v22, v23
    v_add_f32 v30, v30, v31
    v_add_f32 v38, v38, v39
    v_add_f32 v46, v46, v47
    v_mov_b32 v23, v22
    v_mov_b32 v31, v30
    v_mov_b32 v39, v38
    v_mov_b32 v47, v46
    v_permlane32_swap_b32 v23, v22
    v_permlane32_swap_b32 v31, v30
    v_permlane32_swap_b32 v39, v38
    v_permlane32_swap_b32 v47, v46
    v_add_f32 v22, v22, v23
    v_add_f32 v30, v30, v31
    v_add_f32 v38, v38, v39
    v_add_f32 v46, v46, v47
    v_rcp_f32 v22, v22
    v_rcp_f32 v30, v30
    v_rcp_f32 v38, v38
    v_rcp_f32 v46, v46
    v_mul_f32 v20, v20, v160
    v_mul_f32 v21, v21, v164
    v_mul_f32 v28, v28, v161
    v_mul_f32 v29, v29, v165
    v_mul_f32 v36, v36, v162
    v_mul_f32 v37, v37, v166
    v_mul_f32 v44, v44, v163
    v_mul_f32 v45, v45, v167
    v_pk_mul_f32 v[20:21], v[20:21], v[22:23] op_sel_hi:[1,0]
    v_pk_mul_f32 v[28:29], v[28:29], v[30:31] op_sel_hi:[1,0]
    v_pk_mul_f32 v[36:37], v[36:37], v[38:39] op_sel_hi:[1,0]
    v_pk_mul_f32 v[44:45], v[44:45], v[46:47] op_sel_hi:[1,0]
    v_cvt_pk_bf16_f32 v20, v20, v20
    v_cvt_pk_bf16_f32 v21, v21, v21
    v_and_b32 v16, v20, v216
    v_and_b32 v17, v21, v217
    v_and_b32 v18, v20, v218
    v_and_b32 v19, v21, v219
    v_cvt_pk_bf16_f32 v28, v28, v28
    v_cvt_pk_bf16_f32 v29, v29, v29
    v_mfma_f32_16x16x32_bf16 v[48:51], v[192:195], v[16:19], 0
    v_and_b32 v24, v28, v216
    v_and_b32 v25, v29, v217
    v_and_b32 v26, v28, v218
    v_and_b32 v27, v29, v219
    v_mfma_f32_16x16x32_bf16 v[52:55], v[202:205], v[16:19], 0
    v_cvt_pk_bf16_f32 v36, v36, v36
    v_cvt_pk_bf16_f32 v37, v37, v37
    v_mfma_f32_16x16x32_bf16 v[56:59], v[194:197], v[24:27], 0
    v_and_b32 v32, v36, v216
    v_and_b32 v33, v37, v217
    v_and_b32 v34, v36, v218
    v_and_b32 v35, v37, v219
    v_mfma_f32_16x16x32_bf16 v[60:63], v[204:207], v[24:27], 0
    v_cvt_pk_bf16_f32 v44, v44, v44
    v_cvt_pk_bf16_f32 v45, v45, v45
    v_mfma_f32_16x16x32_bf16 v[64:67], v[196:199], v[32:35], 0
    v_and_b32 v40, v44, v216
    v_and_b32 v41, v45, v217
    v_and_b32 v42, v44, v218
    v_and_b32 v43, v45, v219
    v_mfma_f32_16x16x32_bf16 v[68:71], v[206:209], v[32:35], 0
    v_cvt_pk_bf16_f32 v80, v48, v49
    v_cvt_pk_bf16_f32 v81, v50, v51
    v_mfma_f32_16x16x32_bf16 v[72:75], v[198:201], v[40:43], 0
    v_cvt_pk_bf16_f32 v82, v52, v53
    v_cvt_pk_bf16_f32 v83, v54, v55
    buffer_store_dwordx4 v[80:83], v1, s[36:39], s69 offen sc1
    v_mfma_f32_16x16x32_bf16 v[76:79], v[208:211], v[40:43], 0
    v_cvt_pk_bf16_f32 v84, v56, v57
    v_cvt_pk_bf16_f32 v85, v58, v59
    v_cvt_pk_bf16_f32 v86, v60, v61
    v_cvt_pk_bf16_f32 v87, v62, v63
    buffer_store_dwordx4 v[84:87], v1, s[36:39], s70 offen sc1
    v_cvt_pk_bf16_f32 v88, v64, v65
    v_cvt_pk_bf16_f32 v89, v66, v67
    v_cvt_pk_bf16_f32 v90, v68, v69
    v_cvt_pk_bf16_f32 v91, v70, v71
    buffer_store_dwordx4 v[88:91], v1, s[36:39], s71 offen sc1
    v_cvt_pk_bf16_f32 v92, v72, v73
    v_cvt_pk_bf16_f32 v93, v74, v75
    v_cvt_pk_bf16_f32 v94, v76, v77
    v_cvt_pk_bf16_f32 v95, v78, v79
    buffer_store_dwordx4 v[92:95], v1, s[36:39], s72 offen sc1
    v_and_b32 v14, 7, v0
    v_lshlrev_b32 v14, 2, v14
    v_and_b32 v243, 4, v14
    s_lshl_b32 s48, s31, 12
    s_add_u32 s57, s57, s48
    v_lshrrev_b32 v5, 1, v2
    v_lshrrev_b32 v6, 1, v3
    v_xor_b32 v5, v5, v6
    v_and_b32 v6, 1, v3
    v_lshlrev_b32 v6, 3, v6
    v_lshl_add_u32 v5, v5, 4, v6
    v_lshl_add_u32 v5, v2, 7, v5
    v_add_u32 v236, s57, v5
    v_xor_b32 v237, 32, v236
    v_xor_b32 v238, 64, v236
    v_xor_b32 v239, 96, v236
    ds_read_b32 v14, v14 offset:1408
    s_waitcnt vmcnt(4)
L_c_st2:
    v_xor_b32 v15, s28, v233
    v_bitop3_b32 v15, v15, v235, s28 bitop3:0xf6
    v_cmp_ne_u32 vcc, 0, v15
    s_cbranch_vccz L_c_st2ok
    s_sub_u32 s29, s29, 1
    s_cbranch_scc1 L_end
    buffer_load_dwordx2 v[232:233], v220, s[36:39], s59 offen offset:0 sc1
    buffer_load_dwordx2 v[234:235], v220, s[36:39], s59 offen offset:128 sc1
    s_waitcnt vmcnt(0)
    s_branch L_c_st2
L_c_st2ok:
    v_lshlrev_b32 v233, 16, v232
    v_and_b32 v232, 0xffff0000, v232
    v_rcp_f32 v233, v233
    v_lshlrev_b32 v235, 16, v234
    v_and_b32 v234, 0xffff0000, v234
    v_rcp_f32 v235, v235
    s_waitcnt lgkmcnt(0)
    v_not_b32 v14, v14
    v_and_b32 v14, 0x7ff, v14
    v_lshrrev_b32 v7, 5, v14
    v_cmp_eq_u32 vcc, s58, v7
    s_and_b32 s52, vcc_lo, 0xff
    v_mul_f32 v232, v232, v233
    v_add_f32 v233, 1.0, v233
    v_mul_f32 v234, v234, v235
    v_add_f32 v235, 1.0, v235
    v_lshrrev_b32 v4, 2, v0
    v_lshlrev_b32 v4, 7, v4
    v_and_b32 v5, 3, v0
    v_lshl_add_u32 v4, v5, 3, v4
    v_bfe_u32 v5, v0, 3, 2
    v_lshl_add_u32 v4, v5, 5, v4
    v_add_u32 v4, 2048, v4
    v_xor_b32 v5, 32, v4
    v_xor_b32 v6, 64, v4
    v_xor_b32 v7, 96, v4
    v_mov_b32 v246, s28
    v_mov_b32 v242, 0
    v_mov_b32 v9, 1
    s_mov_b64 exec, 1
    s_waitcnt vmcnt(0)
    ds_add_rtn_u32 v9, v242, v9 offset:152
    s_mov_b32 s40, s22
    s_and_b32 s41, s23, 0xffff
    s_mov_b32 s42, 12582912
    s_mov_b32 s43, 0x20000
    s_mov_b32 s44, s20
    s_and_b32 s45, s21, 0xffff
    s_mov_b32 s46, 4194304
    s_mov_b32 s47, 0x20000
    s_and_b32 s60, s27, 7
    s_lshl_b32 s60, s60, 1
    s_lshl_b32 s61, 0x5555, s60
    s_lshl_b32 s48, s58, 16
    s_add_u32 s48, s48, 8388608
    s_waitcnt lgkmcnt(0)
    v_cmp_ne_u32 vcc, 3, v9
    s_cbranch_vccnz L_c_noflag
    buffer_store_dword v246, off, s[36:39], s68 sc1
L_c_noflag:
    s_mov_b64 exec, -1
    v_add_u32 v244, s48, v1
    v_add_u32 v245, 32768, v244
L_rdy_3:
    ds_read_b32 v15, v242 offset:156
    s_waitcnt lgkmcnt(0)
    v_readfirstlane_b32 s62, v15
    s_and_b32 s49, s61, s62
    s_cbranch_scc1 L_c_g0
    s_sub_u32 s29, s29, 1
    s_cbranch_scc1 L_end
    s_branch L_rdy_3
L_c_slow0:
    s_cmp_eq_u32 s61, 0
    s_cselect_b32 s61, -1, s61
    s_cselect_b32 s49, 1, 0
    s_cbranch_scc1 L_c_back0
L_rdy_4:
    ds_read_b32 v15, v242 offset:156
    s_waitcnt lgkmcnt(0)
    v_readfirstlane_b32 s62, v15
    s_and_b32 s49, s61, s62
    s_cbranch_scc1 L_c_back0
    s_sub_u32 s29, s29, 1
    s_cbranch_scc1 L_end
    s_branch L_rdy_4
L_c_slow1:
    s_cmp_eq_u32 s61, 0
    s_cselect_b32 s61, -1, s61
    s_cselect_b32 s49, 1, 0
    s_cbranch_scc1 L_c_back1
L_rdy_5:
    ds_read_b32 v15, v242 offset:156
    s_waitcnt lgkmcnt(0)
    v_readfirstlane_b32 s62, v15
    s_and_b32 s49, s61, s62
    s_cbranch_scc1 L_c_back1
    s_sub_u32 s29, s29, 1
    s_cbranch_scc1 L_end
    s_branch L_rdy_5
L_c_slow2:
    s_cmp_eq_u32 s61, 0
    s_cselect_b32 s61, -1, s61
    s_cselect_b32 s49, 1, 0
    s_cbranch_scc1 L_c_back2
L_rdy_6:
    ds_read_b32 v15, v242 offset:156
    s_waitcnt lgkmcnt(0)
    v_readfirstlane_b32 s62, v15
    s_and_b32 s49, s61, s62
    s_cbranch_scc1 L_c_back2
    s_sub_u32 s29, s29, 1
    s_cbranch_scc1 L_end
    s_branch L_rdy_6
    s_nop 0
L_c_g0:
    s_ff1_i32_b32 s49, s49
    s_bitset0_b32 s61, s49
    s_lshl_b32 s63, s49, 11
    s_bitset0_b32 s63, 15
    buffer_load_dwordx4 v[80:83], v244, s[40:43], s63 offen offset:0 sc1
    buffer_load_dwordx4 v[84:87], v245, s[40:43], s63 offen offset:0 sc1
    buffer_load_dwordx4 v[88:91], v244, s[40:43], s63 offen offset:1024 sc1
    buffer_load_dwordx4 v[92:95], v245, s[40:43], s63 offen offset:1024 sc1
    buffer_load_dwordx4 v[96:99], v244, s[40:43], s63 offen offset:2048 sc1
    buffer_load_dwordx4 v[100:103], v245, s[40:43], s63 offen offset:2048 sc1
    buffer_load_dwordx4 v[104:107], v244, s[40:43], s63 offen offset:3072 sc1
    buffer_load_dwordx4 v[108:111], v245, s[40:43], s63 offen offset:3072 sc1
    s_lshl_b32 s64, s63, 2
L_lw_7:
    ds_read_b32 v15, v243 offset:128
    s_waitcnt lgkmcnt(0)
    v_cmp_gt_u32 vcc, 1, v15
    s_cbranch_vccz L_lwe_8
    s_sub_u32 s29, s29, 1
    s_cbranch_scc1 L_end
    s_branch L_lw_7
    s_nop 0
L_lwe_8:
    ds_read_b64 v[144:145], v236 offset:0
    ds_read_b64 v[146:147], v237 offset:0
    ds_read_b64 v[148:149], v238 offset:0
    ds_read_b64 v[150:151], v239 offset:0
    ds_read_b64 v[152:153], v236 offset:2048
    ds_read_b64 v[154:155], v237 offset:2048
    ds_read_b64 v[156:157], v238 offset:2048
    ds_read_b64 v[158:159], v239 offset:2048
    v_add_u32 v8, s64, v4
    v_add_u32 v9, s64, v5
    v_add_u32 v10, s64, v6
    v_add_u32 v11, s64, v7
    ds_read_b64_tr_b16 v[48:49], v8 offset:0
    ds_read_b64_tr_b16 v[50:51], v8 offset:2048
    ds_read_b64_tr_b16 v[52:53], v9 offset:0
    ds_read_b64_tr_b16 v[54:55], v9 offset:2048
    ds_read_b64_tr_b16 v[56:57], v10 offset:0
    ds_read_b64_tr_b16 v[58:59], v10 offset:2048
    ds_read_b64_tr_b16 v[60:61], v11 offset:0
    ds_read_b64_tr_b16 v[62:63], v11 offset:2048
    ds_read_b64_tr_b16 v[64:65], v8 offset:4096
    ds_read_b64_tr_b16 v[66:67], v8 offset:6144
    ds_read_b64_tr_b16 v[68:69], v9 offset:4096
    ds_read_b64_tr_b16 v[70:71], v9 offset:6144
    ds_read_b64_tr_b16 v[72:73], v10 offset:4096
    ds_read_b64_tr_b16 v[74:75], v10 offset:6144
    s_waitcnt lgkmcnt(14)
    v_lshlrev_b32 v16, 16, v144
    v_and_b32 v17, 0xffff0000, v144
    v_lshlrev_b32 v18, 16, v145
    v_and_b32 v19, 0xffff0000, v145
    v_lshlrev_b32 v20, 16, v146
    v_and_b32 v21, 0xffff0000, v146
    v_lshlrev_b32 v22, 16, v147
    v_and_b32 v23, 0xffff0000, v147
    v_lshlrev_b32 v24, 16, v148
    v_and_b32 v25, 0xffff0000, v148
    v_lshlrev_b32 v26, 16, v149
    v_and_b32 v27, 0xffff0000, v149
    v_lshlrev_b32 v28, 16, v150
    v_and_b32 v29, 0xffff0000, v150
    v_lshlrev_b32 v30, 16, v151
    v_and_b32 v31, 0xffff0000, v151
    v_lshlrev_b32 v32, 16, v152
    v_and_b32 v33, 0xffff0000, v152
    v_lshlrev_b32 v34, 16, v153
    v_and_b32 v35, 0xffff0000, v153
    v_lshlrev_b32 v36, 16, v154
    v_and_b32 v37, 0xffff0000, v154
    v_lshlrev_b32 v38, 16, v155
    v_and_b32 v39, 0xffff0000, v155
    v_lshlrev_b32 v40, 16, v156
    v_and_b32 v41, 0xffff0000, v156
    v_lshlrev_b32 v42, 16, v157
    v_and_b32 v43, 0xffff0000, v157
    v_lshlrev_b32 v44, 16, v158
    v_and_b32 v45, 0xffff0000, v158
    v_lshlrev_b32_e64 v46, 16, v159
    v_and_b32 v47, 0xffff0000, v159
    v_pk_fma_f32 v[16:17], v[232:233], v[16:17], v[232:233] op_sel:[1,0,0] op_sel_hi:[1,1,0] neg_lo:[0,0,1] neg_hi:[0,0,1]
    v_pk_fma_f32 v[18:19], v[232:233], v[18:19], v[232:233] op_sel:[1,0,0] op_sel_hi:[1,1,0] neg_lo:[0,0,1] neg_hi:[0,0,1]
    v_pk_fma_f32 v[20:21], v[232:233], v[20:21], v[232:233] op_sel:[1,0,0] op_sel_hi:[1,1,0] neg_lo:[0,0,1] neg_hi:[0,0,1]
    v_pk_fma_f32 v[22:23], v[232:233], v[22:23], v[232:233] op_sel:[1,0,0] op_sel_hi:[1,1,0] neg_lo:[0,0,1] neg_hi:[0,0,1]
    v_pk_fma_f32 v[24:25], v[232:233], v[24:25], v[232:233] op_sel:[1,0,0] op_sel_hi:[1,1,0] neg_lo:[0,0,1] neg_hi:[0,0,1]
    v_pk_fma_f32 v[26:27], v[232:233], v[26:27], v[232:233] op_sel:[1,0,0] op_sel_hi:[1,1,0] neg_lo:[0,0,1] neg_hi:[0,0,1]
    v_pk_fma_f32 v[28:29], v[232:233], v[28:29], v[232:233] op_sel:[1,0,0] op_sel_hi:[1,1,0] neg_lo:[0,0,1] neg_hi:[0,0,1]
    v_pk_fma_f32 v[30:31], v[232:233], v[30:31], v[232:233] op_sel:[1,0,0] op_sel_hi:[1,1,0] neg_lo:[0,0,1] neg_hi:[0,0,1]
    v_pk_fma_f32 v[32:33], v[234:235], v[32:33], v[234:235] op_sel:[1,0,0] op_sel_hi:[1,1,0] neg_lo:[0,0,1] neg_hi:[0,0,1]
    v_pk_fma_f32 v[34:35], v[234:235], v[34:35], v[234:235] op_sel:[1,0,0] op_sel_hi:[1,1,0] neg_lo:[0,0,1] neg_hi:[0,0,1]
    v_pk_fma_f32 v[36:37], v[234:235], v[36:37], v[234:235] op_sel:[1,0,0] op_sel_hi:[1,1,0] neg_lo:[0,0,1] neg_hi:[0,0,1]
    v_pk_fma_f32 v[38:39], v[234:235], v[38:39], v[234:235] op_sel:[1,0,0] op_sel_hi:[1,1,0] neg_lo:[0,0,1] neg_hi:[0,0,1]
    v_pk_fma_f32 v[40:41], v[234:235], v[40:41], v[234:235] op_sel:[1,0,0] op_sel_hi:[1,1,0] neg_lo:[0,0,1] neg_hi:[0,0,1]
    v_pk_fma_f32 v[42:43], v[234:235], v[42:43], v[234:235] op_sel:[1,0,0] op_sel_hi:[1,1,0] neg_lo:[0,0,1] neg_hi:[0,0,1]
    v_pk_fma_f32 v[44:45], v[234:235], v[44:45], v[234:235] op_sel:[1,0,0] op_sel_hi:[1,1,0] neg_lo:[0,0,1] neg_hi:[0,0,1]
    v_pk_fma_f32 v[46:47], v[234:235], v[46:47], v[234:235] op_sel:[1,0,0] op_sel_hi:[1,1,0] neg_lo:[0,0,1] neg_hi:[0,0,1]
    s_and_b32 s49, s61, s62
    s_cbranch_scc0 L_c_slow2
L_c_back2:
    s_ff1_i32_b32 s49, s49
    s_bitset0_b32 s61, s49
    s_lshl_b32 s63, s49, 11
    s_bitset0_b32 s63, 15
    buffer_load_dwordx4 v[112:115], v244, s[40:43], s63 offen offset:0 sc1
    buffer_load_dwordx4 v[116:119], v245, s[40:43], s63 offen offset:0 sc1
    buffer_load_dwordx4 v[120:123], v244, s[40:43], s63 offen offset:1024 sc1
    buffer_load_dwordx4 v[124:127], v245, s[40:43], s63 offen offset:1024 sc1
    buffer_load_dwordx4 v[128:131], v244, s[40:43], s63 offen offset:2048 sc1
    buffer_load_dwordx4 v[132:135], v245, s[40:43], s63 offen offset:2048 sc1
    s_mov_b32 s53, 0
    s_and_b32 s49, s61, s62
    s_cbranch_scc1 L_c_pre
L_rdy_9:
    ds_read_b32 v15, v242 offset:156
    s_waitcnt lgkmcnt(0)
    v_readfirstlane_b32 s62, v15
    s_and_b32 s49, s61, s62
    s_cbranch_scc1 L_c_pre
    s_sub_u32 s29, s29, 1
    s_cbranch_scc1 L_end
    s_branch L_rdy_9
L_c_pre:
    s_ff1_i32_b32 s49, s49
    s_waitcnt vmcnt(12) lgkmcnt(10)
L_c_k2loop:
    v_mfma_f32_16x16x32_bf16 v[16:19], v[48:51], v[80:83], v[16:19]
    ds_read_b64_tr_b16 v[76:77], v11 offset:4096
    buffer_load_dwordx4 v[136:139], v244, s[40:43], s63 offen offset:3072 sc1
    v_mfma_f32_16x16x32_bf16 v[32:35], v[48:51], v[84:87], v[32:35]
    ds_read_b64_tr_b16 v[78:79], v11 offset:6144
    buffer_load_dwordx4 v[140:143], v245, s[40:43], s63 offen offset:3072 sc1
    s_cmp_eq_u32 s53, 3
    s_cselect_b32 s42, 0, s42
    v_mfma_f32_16x16x32_bf16 v[20:23], v[52:55], v[80:83], v[20:23]
    ds_read_b64_tr_b16 v[48:49], v8 offset:8192
    s_lshl_b32 s64, s63, 2
    v_mfma_f32_16x16x32_bf16 v[36:39], v[52:55], v[84:87], v[36:39]
    ds_read_b64_tr_b16 v[50:51], v8 offset:10240
    s_waitcnt lgkmcnt(10)
    v_mfma_f32_16x16x32_bf16 v[24:27], v[56:59], v[80:83], v[24:27]
    ds_read_b64_tr_b16 v[52:53], v9 offset:8192
    s_bitset0_b32 s61, s49
    v_mfma_f32_16x16x32_bf16 v[40:43], v[56:59], v[84:87], v[40:43]
    ds_read_b64_tr_b16 v[54:55], v9 offset:10240
    s_lshl_b32 s63, s49, 11
    v_mfma_f32_16x16x32_bf16 v[28:31], v[60:63], v[80:83], v[28:31]
    ds_read_b64_tr_b16 v[56:57], v10 offset:8192
    s_bitset0_b32 s63, 15
    v_mfma_f32_16x16x32_bf16 v[44:47], v[60:63], v[84:87], v[44:47]
    ds_read_b64_tr_b16 v[58:59], v10 offset:10240
    s_waitcnt vmcnt(12) lgkmcnt(10)
    v_mfma_f32_16x16x32_bf16 v[16:19], v[64:67], v[88:91], v[16:19]
    ds_read_b64_tr_b16 v[60:61], v11 offset:8192
    buffer_load_dwordx4 v[80:83], v244, s[40:43], s63 offen offset:0 sc1
    v_mfma_f32_16x16x32_bf16 v[32:35], v[64:67], v[92:95], v[32:35]
    ds_read_b64_tr_b16 v[62:63], v11 offset:10240
    buffer_load_dwordx4 v[84:87], v245, s[40:43], s63 offen offset:0 sc1
    v_mfma_f32_16x16x32_bf16 v[20:23], v[68:71], v[88:91], v[20:23]
    ds_read_b64_tr_b16 v[64:65], v8 offset:12288
    s_add_u32 s53, s53, 1
    v_mfma_f32_16x16x32_bf16 v[36:39], v[68:71], v[92:95], v[36:39]
    ds_read_b64_tr_b16 v[66:67], v8 offset:14336
    s_waitcnt lgkmcnt(10)
    v_mfma_f32_16x16x32_bf16 v[24:27], v[72:75], v[88:91], v[24:27]
    ds_read_b64_tr_b16 v[68:69], v9 offset:12288
    v_mfma_f32_16x16x32_bf16 v[40:43], v[72:75], v[92:95], v[40:43]
    ds_read_b64_tr_b16 v[70:71], v9 offset:14336
    v_add_u32 v8, s64, v4
    v_mfma_f32_16x16x32_bf16 v[28:31], v[76:79], v[88:91], v[28:31]
    ds_read_b64_tr_b16 v[72:73], v10 offset:12288
    v_add_u32 v9, s64, v5
    v_mfma_f32_16x16x32_bf16 v[44:47], v[76:79], v[92:95], v[44:47]
    ds_read_b64_tr_b16 v[74:75], v10 offset:14336
    s_waitcnt vmcnt(12) lgkmcnt(10)
    v_mfma_f32_16x16x32_bf16 v[16:19], v[48:51], v[96:99], v[16:19]
    ds_read_b64_tr_b16 v[76:77], v11 offset:12288
    buffer_load_dwordx4 v[88:91], v244, s[40:43], s63 offen offset:1024 sc1
    v_mfma_f32_16x16x32_bf16 v[32:35], v[48:51], v[100:103], v[32:35]
    ds_read_b64_tr_b16 v[78:79], v11 offset:14336
    buffer_load_dwordx4 v[92:95], v245, s[40:43], s63 offen offset:1024 sc1
    v_mfma_f32_16x16x32_bf16 v[20:23], v[52:55], v[96:99], v[20:23]
    ds_read_b64_tr_b16 v[48:49], v8 offset:0
    v_add_u32 v10, s64, v6
    v_mfma_f32_16x16x32_bf16 v[36:39], v[52:55], v[100:103], v[36:39]
    ds_read_b64_tr_b16 v[50:51], v8 offset:2048
    s_waitcnt lgkmcnt(10)
    v_mfma_f32_16x16x32_bf16 v[24:27], v[56:59], v[96:99], v[24:27]
    ds_read_b64_tr_b16 v[52:53], v9 offset:0
    v_add_u32 v11, s64, v7
    v_mfma_f32_16x16x32_bf16 v[40:43], v[56:59], v[100:103], v[40:43]
    ds_read_b64_tr_b16 v[54:55], v9 offset:2048
    v_mfma_f32_16x16x32_bf16 v[28:31], v[60:63], v[96:99], v[28:31]
    ds_read_b64_tr_b16 v[56:57], v10 offset:0
    v_mfma_f32_16x16x32_bf16 v[44:47], v[60:63], v[100:103], v[44:47]
    ds_read_b64_tr_b16 v[58:59], v10 offset:2048
    s_waitcnt vmcnt(12) lgkmcnt(10)
    v_mfma_f32_16x16x32_bf16 v[16:19], v[64:67], v[104:107], v[16:19]
    ds_read_b64_tr_b16 v[60:61], v11 offset:0
    buffer_load_dwordx4 v[96:99], v244, s[40:43], s63 offen offset:2048 sc1
    v_mfma_f32_16x16x32_bf16 v[32:35], v[64:67], v[108:111], v[32:35]
    ds_read_b64_tr_b16 v[62:63], v11 offset:2048
    buffer_load_dwordx4 v[100:103], v245, s[40:43], s63 offen offset:2048 sc1
    v_mfma_f32_16x16x32_bf16 v[20:23], v[68:71], v[104:107], v[20:23]
    ds_read_b64_tr_b16 v[64:65], v8 offset:4096
    s_and_b32 s49, s61, s62
    v_mfma_f32_16x16x32_bf16 v[36:39], v[68:71], v[108:111], v[36:39]
    ds_read_b64_tr_b16 v[66:67], v8 offset:6144
    s_waitcnt lgkmcnt(10)
    v_mfma_f32_16x16x32_bf16 v[24:27], v[72:75], v[104:107], v[24:27]
    ds_read_b64_tr_b16 v[68:69], v9 offset:4096
    s_cbranch_scc0 L_c_slow0
L_c_back0:
    v_mfma_f32_16x16x32_bf16 v[40:43], v[72:75], v[108:111], v[40:43]
    ds_read_b64_tr_b16 v[70:71], v9 offset:6144
    s_ff1_i32_b32 s49, s49
    v_mfma_f32_16x16x32_bf16 v[28:31], v[76:79], v[104:107], v[28:31]
    ds_read_b64_tr_b16 v[72:73], v10 offset:4096
    v_mfma_f32_16x16x32_bf16 v[44:47], v[76:79], v[108:111], v[44:47]
    ds_read_b64_tr_b16 v[74:75], v10 offset:6144
    s_waitcnt vmcnt(12) lgkmcnt(10)
    v_mfma_f32_16x16x32_bf16 v[16:19], v[48:51], v[112:115], v[16:19]
    ds_read_b64_tr_b16 v[76:77], v11 offset:4096
    buffer_load_dwordx4 v[104:107], v244, s[40:43], s63 offen offset:3072 sc1
    v_mfma_f32_16x16x32_bf16 v[32:35], v[48:51], v[116:119], v[32:35]
    ds_read_b64_tr_b16 v[78:79], v11 offset:6144
    buffer_load_dwordx4 v[108:111], v245, s[40:43], s63 offen offset:3072 sc1
    v_mfma_f32_16x16x32_bf16 v[20:23], v[52:55], v[112:115], v[20:23]
    ds_read_b64_tr_b16 v[48:49], v8 offset:8192
    s_lshl_b32 s64, s63, 2
    v_mfma_f32_16x16x32_bf16 v[36:39], v[52:55], v[116:119], v[36:39]
    ds_read_b64_tr_b16 v[50:51], v8 offset:10240
    s_waitcnt lgkmcnt(10)
    v_mfma_f32_16x16x32_bf16 v[24:27], v[56:59], v[112:115], v[24:27]
    ds_read_b64_tr_b16 v[52:53], v9 offset:8192
    s_bitset0_b32 s61, s49
    v_mfma_f32_16x16x32_bf16 v[40:43], v[56:59], v[116:119], v[40:43]
    ds_read_b64_tr_b16 v[54:55], v9 offset:10240
    s_lshl_b32 s63, s49, 11
    v_mfma_f32_16x16x32_bf16 v[28:31], v[60:63], v[112:115], v[28:31]
    ds_read_b64_tr_b16 v[56:57], v10 offset:8192
    s_bitset0_b32 s63, 15
    v_mfma_f32_16x16x32_bf16 v[44:47], v[60:63], v[116:119], v[44:47]
    ds_read_b64_tr_b16 v[58:59], v10 offset:10240
    s_waitcnt vmcnt(12) lgkmcnt(10)
    v_mfma_f32_16x16x32_bf16 v[16:19], v[64:67], v[120:123], v[16:19]
    ds_read_b64_tr_b16 v[60:61], v11 offset:8192
    buffer_load_dwordx4 v[112:115], v244, s[40:43], s63 offen offset:0 sc1
    v_mfma_f32_16x16x32_bf16 v[32:35], v[64:67], v[124:127], v[32:35]
    ds_read_b64_tr_b16 v[62:63], v11 offset:10240
    buffer_load_dwordx4 v[116:119], v245, s[40:43], s63 offen offset:0 sc1
    v_mfma_f32_16x16x32_bf16 v[20:23], v[68:71], v[120:123], v[20:23]
    ds_read_b64_tr_b16 v[64:65], v8 offset:12288
    v_mfma_f32_16x16x32_bf16 v[36:39], v[68:71], v[124:127], v[36:39]
    ds_read_b64_tr_b16 v[66:67], v8 offset:14336
    s_waitcnt lgkmcnt(10)
    v_mfma_f32_16x16x32_bf16 v[24:27], v[72:75], v[120:123], v[24:27]
    ds_read_b64_tr_b16 v[68:69], v9 offset:12288
    v_mfma_f32_16x16x32_bf16 v[40:43], v[72:75], v[124:127], v[40:43]
    ds_read_b64_tr_b16 v[70:71], v9 offset:14336
    v_add_u32 v8, s64, v4
    v_mfma_f32_16x16x32_bf16 v[28:31], v[76:79], v[120:123], v[28:31]
    ds_read_b64_tr_b16 v[72:73], v10 offset:12288
    v_add_u32 v9, s64, v5
    v_mfma_f32_16x16x32_bf16 v[44:47], v[76:79], v[124:127], v[44:47]
    ds_read_b64_tr_b16 v[74:75], v10 offset:14336
    s_waitcnt vmcnt(12) lgkmcnt(10)
    v_mfma_f32_16x16x32_bf16 v[16:19], v[48:51], v[128:131], v[16:19]
    ds_read_b64_tr_b16 v[76:77], v11 offset:12288
    buffer_load_dwordx4 v[120:123], v244, s[40:43], s63 offen offset:1024 sc1
    v_mfma_f32_16x16x32_bf16 v[32:35], v[48:51], v[132:135], v[32:35]
    ds_read_b64_tr_b16 v[78:79], v11 offset:14336
    buffer_load_dwordx4 v[124:127], v245, s[40:43], s63 offen offset:1024 sc1
    v_mfma_f32_16x16x32_bf16 v[20:23], v[52:55], v[128:131], v[20:23]
    ds_read_b64_tr_b16 v[48:49], v8 offset:0
    v_add_u32 v10, s64, v6
    v_mfma_f32_16x16x32_bf16 v[36:39], v[52:55], v[132:135], v[36:39]
    ds_read_b64_tr_b16 v[50:51], v8 offset:2048
    s_waitcnt lgkmcnt(10)
    v_mfma_f32_16x16x32_bf16 v[24:27], v[56:59], v[128:131], v[24:27]
    ds_read_b64_tr_b16 v[52:53], v9 offset:0
    v_add_u32 v11, s64, v7
    v_mfma_f32_16x16x32_bf16 v[40:43], v[56:59], v[132:135], v[40:43]
    ds_read_b64_tr_b16 v[54:55], v9 offset:2048
    v_mfma_f32_16x16x32_bf16 v[28:31], v[60:63], v[128:131], v[28:31]
    ds_read_b64_tr_b16 v[56:57], v10 offset:0
    v_mfma_f32_16x16x32_bf16 v[44:47], v[60:63], v[132:135], v[44:47]
    ds_read_b64_tr_b16 v[58:59], v10 offset:2048
    s_waitcnt vmcnt(12) lgkmcnt(10)
    v_mfma_f32_16x16x32_bf16 v[16:19], v[64:67], v[136:139], v[16:19]
    ds_read_b64_tr_b16 v[60:61], v11 offset:0
    buffer_load_dwordx4 v[128:131], v244, s[40:43], s63 offen offset:2048 sc1
    v_mfma_f32_16x16x32_bf16 v[32:35], v[64:67], v[140:143], v[32:35]
    ds_read_b64_tr_b16 v[62:63], v11 offset:2048
    buffer_load_dwordx4 v[132:135], v245, s[40:43], s63 offen offset:2048 sc1
    v_mfma_f32_16x16x32_bf16 v[20:23], v[68:71], v[136:139], v[20:23]
    ds_read_b64_tr_b16 v[64:65], v8 offset:4096
    s_and_b32 s49, s61, s62
    v_mfma_f32_16x16x32_bf16 v[36:39], v[68:71], v[140:143], v[36:39]
    ds_read_b64_tr_b16 v[66:67], v8 offset:6144
    s_waitcnt lgkmcnt(10)
    v_mfma_f32_16x16x32_bf16 v[24:27], v[72:75], v[136:139], v[24:27]
    ds_read_b64_tr_b16 v[68:69], v9 offset:4096
    s_cbranch_scc0 L_c_slow1
L_c_back1:
    v_mfma_f32_16x16x32_bf16 v[40:43], v[72:75], v[140:143], v[40:43]
    ds_read_b64_tr_b16 v[70:71], v9 offset:6144
    s_ff1_i32_b32 s49, s49
    v_mfma_f32_16x16x32_bf16 v[28:31], v[76:79], v[136:139], v[28:31]
    ds_read_b64_tr_b16 v[72:73], v10 offset:4096
    s_cmp_lt_u32 s53, 4
    v_mfma_f32_16x16x32_bf16 v[44:47], v[76:79], v[140:143], v[44:47]
    ds_read_b64_tr_b16 v[74:75], v10 offset:6144
    s_waitcnt vmcnt(12) lgkmcnt(10)
    s_cbranch_scc1 L_c_k2loop
    s_cmp_eq_u32 s52, 0
    s_cbranch_scc1 L_c_fin
    v_lshlrev_b32 v6, 4, v3
L_lw_10:
    ds_read_b32 v15, v243 offset:144
    s_waitcnt lgkmcnt(0)
    v_cmp_gt_u32 vcc, 1, v15
    s_cbranch_vccz L_lwe_11
    s_sub_u32 s29, s29, 1
    s_cbranch_scc1 L_end
    s_branch L_lw_10
L_lwe_11:
L_c_upd:
    s_ff1_i32_b32 s48, s52
    s_bitset0_b32 s52, s48
    v_readlane_b32 s49, v14, s48
    s_lshl_b32 s48, s48, 8
    s_add_u32 s48, s48, 155648
    v_add_u32 v7, s48, v6
    ds_read_b128 v[144:147], v7 offset:0
    ds_read_b128 v[148:151], v7 offset:64
    ds_read_b128 v[152:155], v7 offset:128
    ds_read_b128 v[156:159], v7 offset:192
    ds_read_b128 v[160:163], v7 offset:2048
    ds_read_b128 v[164:167], v7 offset:2112
    ds_read_b128 v[168:171], v7 offset:2176
    ds_read_b128 v[172:175], v7 offset:2240
    s_and_b32 s48, s49, 15
    v_cmp_eq_u32_e64 vcc, s48, v2
    s_waitcnt lgkmcnt(0)
    v_pk_add_f32 v[144:145], v[144:145], v[160:161]
    v_pk_add_f32 v[146:147], v[146:147], v[162:163]
    v_pk_add_f32 v[148:149], v[148:149], v[164:165]
    v_pk_add_f32 v[150:151], v[150:151], v[166:167]
    v_pk_add_f32 v[152:153], v[152:153], v[168:169]
    v_pk_add_f32 v[154:155], v[154:155], v[170:171]
    v_pk_add_f32 v[156:157], v[156:157], v[172:173]
    v_pk_add_f32 v[158:159], v[158:159], v[174:175]
    s_mov_b64 exec, vcc
    s_bitcmp1_b32 s49, 4
    s_cbranch_scc1 L_c_upd1
    v_pk_add_f32 v[16:17], v[16:17], v[144:145]
    v_pk_add_f32 v[18:19], v[18:19], v[146:147]
    v_pk_add_f32 v[20:21], v[20:21], v[148:149]
    v_pk_add_f32 v[22:23], v[22:23], v[150:151]
    v_pk_add_f32 v[24:25], v[24:25], v[152:153]
    v_pk_add_f32 v[26:27], v[26:27], v[154:155]
    v_pk_add_f32 v[28:29], v[28:29], v[156:157]
    v_pk_add_f32 v[30:31], v[30:31], v[158:159]
    s_branch L_c_upd2
L_c_upd1:
    v_pk_add_f32 v[32:33], v[32:33], v[144:145]
    v_pk_add_f32 v[34:35], v[34:35], v[146:147]
    v_pk_add_f32 v[36:37], v[36:37], v[148:149]
    v_pk_add_f32 v[38:39], v[38:39], v[150:151]
    v_pk_add_f32 v[40:41], v[40:41], v[152:153]
    v_pk_add_f32 v[42:43], v[42:43], v[154:155]
    v_pk_add_f32 v[44:45], v[44:45], v[156:157]
    v_pk_add_f32 v[46:47], v[46:47], v[158:159]
L_c_upd2:
    s_mov_b64 exec, -1
    s_cmp_lg_u32 s52, 0
    s_cbranch_scc1 L_c_upd
L_c_fin:
    v_add_u32 v4, s57, v1
    v_cvt_pk_bf16_f32 v176, v16, v17
    v_cvt_pk_bf16_f32 v177, v18, v19
    ds_write_b64 v236, v[176:177] offset:0
    v_cvt_pk_bf16_f32 v178, v20, v21
    v_cvt_pk_bf16_f32 v179, v22, v23
    ds_write_b64 v237, v[178:179] offset:0
    v_cvt_pk_bf16_f32 v180, v24, v25
    v_cvt_pk_bf16_f32 v181, v26, v27
    ds_write_b64 v238, v[180:181] offset:0
    v_cvt_pk_bf16_f32 v182, v28, v29
    v_cvt_pk_bf16_f32 v183, v30, v31
    ds_write_b64 v239, v[182:183] offset:0
    ds_read_b128 v[192:195], v4 offset:0
    ds_read_b128 v[196:199], v4 offset:1024
    v_cvt_pk_bf16_f32 v184, v32, v33
    v_cvt_pk_bf16_f32 v185, v34, v35
    ds_write_b64 v236, v[184:185] offset:2048
    v_cvt_pk_bf16_f32 v186, v36, v37
    v_cvt_pk_bf16_f32 v187, v38, v39
    ds_write_b64 v237, v[186:187] offset:2048
    v_cvt_pk_bf16_f32 v188, v40, v41
    v_cvt_pk_bf16_f32 v189, v42, v43
    ds_write_b64 v238, v[188:189] offset:2048
    v_cvt_pk_bf16_f32 v190, v44, v45
    v_cvt_pk_bf16_f32 v191, v46, v47
    ds_write_b64 v239, v[190:191] offset:2048
    ds_read_b128 v[200:203], v4 offset:2048
    ds_read_b128 v[204:207], v4 offset:3072
    s_waitcnt lgkmcnt(7)
    buffer_store_dwordx4 v[192:195], v12, s[44:47], s56 offen sc1
    s_add_u32 s56, s56, 16384
    s_waitcnt lgkmcnt(6)
    buffer_store_dwordx4 v[196:199], v13, s[44:47], s56 offen sc1
    s_add_u32 s56, s56, 16384
    s_waitcnt lgkmcnt(1)
    buffer_store_dwordx4 v[200:203], v12, s[44:47], s56 offen sc1
    s_add_u32 s56, s56, 16384
    s_waitcnt lgkmcnt(0)
    buffer_store_dwordx4 v[204:207], v13, s[44:47], s56 offen sc1
    s_add_u32 s56, s56, 16384
    s_endpgm
L_ffn:
    s_waitcnt lgkmcnt(0)
    s_barrier
    s_mul_i32 s28, s28, 0x9E3779B1
    s_add_u32 s28, s28, 0x7F4A7C15
    v_lshlrev_b32 v5, 3, v0
    s_lshl_b32 s48, s3, 2
    v_add_u32 v6, s48, v5
    ds_read_b32 v8, v6 offset:1440
    v_mov_b32 v9, s28
    s_lshl_b32 s48, s3, 16
    s_lshl_b32 s49, s59, 3
    s_add_u32 s48, s48, s49
    s_add_u32 s48, s48, 65536
    s_mov_b64 exec, 0xff
    s_waitcnt lgkmcnt(0)
    buffer_store_dwordx2 v[8:9], v5, s[36:39], s48 offen sc1
    s_mov_b64 exec, 1
    ds_write_b32 v5, v9 offset:1504
    s_mov_b64 exec, -1
    s_and_b32 s26, s24, 8
    s_bfe_u32 s48, s2, 0x10001
    s_lshl_b32 s48, s48, 2
    s_add_u32 s26, s26, s48
    s_bfe_u32 s48, s2, 0x20003
    s_add_u32 s26, s26, s48
    s_bfe_u32 s27, s2, 0x10002
    s_lshl_b32 s27, s27, 3
    s_lshr_b32 s48, s2, 5
    s_add_u32 s27, s27, s48
    s_and_b32 s48, s25, 7
    s_cmp_lg_u32 s48, 3
    s_cselect_b32 s69, 1, 0
    s_add_u32 s48, s25, 4
    s_lshr_b32 s48, s48, 3
    s_sub_u32 s48, s25, s48
    s_lshl_b32 s48, s48, 4
    s_add_u32 s58, s48, s24
    s_lshr_b32 s56, s58, 2
    s_and_b32 s57, s58, 3
    s_lshl_b32 s48, s3, 2
    s_add_u32 s48, s48, 128
    v_lshlrev_b32 v4, 2, v0
    v_add_u32 v4, 1536, v4
    v_writelane_b32 v4, s48, 0
    s_mov_b32 s44, s18
    s_and_b32 s45, s19, 0xffff
    s_mov_b32 s46, 7340032
    s_mov_b32 s47, 0x20000
    s_lshl_b32 s54, s56, 17
    s_lshl_b32 s50, s57, 9
    s_add_u32 s54, s54, s50
    s_lshl_b32 s50, s3, 8
    s_add_u32 s54, s54, s50
    v_and_b32 v6, 7, v0
    v_lshrrev_b32 v5, 3, v0
    v_and_b32 v2, 6, v5
    v_xor_b32 v2, v2, v6
    v_lshlrev_b32 v5, 11, v5
    v_lshl_add_u32 v2, v2, 4, v5
    v_lshrrev_b32 v7, 4, v0
    s_lshl_b32 s59, s3, 14
    s_add_u32 s59, s59, 131072
    s_lshl_b32 s48, s24, 7
    s_sub_u32 s48, s48, 16
    v_add_u32 v16, s48, v0
    v_lshlrev_b32 v17, 3, v16
    v_max_i32 v16, 0, v17
    v_add_u32 v17, 512, v17
    v_and_b32 v19, 15, v0
    v_add_u32 v18, s48, v19
    v_lshlrev_b32 v18, 3, v18
    v_add_u32 v18, 1024, v18
    s_mov_b32 s55, 131072
    v_lshrrev_b32 v12, 4, v0
    v_bfe_u32 v13, v0, 2, 2
    v_lshl_add_u32 v12, v12, 3, v13
    v_lshlrev_b32 v12, 7, v12
    v_and_b32 v13, 3, v0
    v_lshl_add_u32 v12, v13, 3, v12
    v_bfe_u32 v13, v0, 3, 2
    v_lshl_add_u32 v12, v13, 5, v12
    v_add_u32 v12, s59, v12
    v_xor_b32 v13, 32, v12
    v_xor_b32_e64 v14, 64, v12
    v_xor_b32 v15, 96, v12
    s_waitcnt lgkmcnt(0)
    s_barrier
    s_waitcnt lgkmcnt(0)
    s_barrier
    s_sleep 10
    s_mov_b32 s53, 0
    s_cmp_eq_u32 s3, 1
    s_cbranch_scc1 L_f1
L_f_keys:
    s_mov_b32 s48, 65536
    buffer_load_dwordx4 v[64:67], v1, s[36:39], s48 offen offset:0 sc1
    buffer_load_dwordx4 v[68:71], v1, s[36:39], s48 offen offset:1024 sc1
    buffer_load_dwordx4 v[72:75], v1, s[36:39], s48 offen offset:2048 sc1
    buffer_load_dwordx4 v[76:79], v1, s[36:39], s48 offen offset:3072 sc1
    s_mov_b32 s48, 69632
    buffer_load_dwordx4 v[80:83], v1, s[36:39], s48 offen offset:0 sc1
    buffer_load_dwordx4 v[84:87], v1, s[36:39], s48 offen offset:1024 sc1
    buffer_load_dwordx4 v[88:91], v1, s[36:39], s48 offen offset:2048 sc1
    buffer_load_dwordx4 v[92:95], v1, s[36:39], s48 offen offset:3072 sc1
    s_mov_b32 s48, 73728
    buffer_load_dwordx4 v[96:99], v1, s[36:39], s48 offen offset:0 sc1
    buffer_load_dwordx4 v[100:103], v1, s[36:39], s48 offen offset:1024 sc1
    buffer_load_dwordx4 v[104:107], v1, s[36:39], s48 offen offset:2048 sc1
    buffer_load_dwordx4 v[108:111], v1, s[36:39], s48 offen offset:3072 sc1
    s_mov_b32 s48, 77824
    buffer_load_dwordx4 v[112:115], v1, s[36:39], s48 offen offset:0 sc1
    buffer_load_dwordx4 v[116:119], v1, s[36:39], s48 offen offset:1024 sc1
    buffer_load_dwordx4 v[120:123], v1, s[36:39], s48 offen offset:2048 sc1
    buffer_load_dwordx4 v[124:127], v1, s[36:39], s48 offen offset:3072 sc1
    s_cmp_lg_u32 s53, 0
    s_cbranch_scc1 L_f_keys2
    s_barrier
L_f_keys2:
    s_waitcnt vmcnt(0)
    s_mov_b32 s53, 1
    v_xor_b32 v5, s28, v65
    v_bitop3_b32 v5, v5, v67, s28 bitop3:0xf6
    v_bitop3_b32 v5, v5, v69, s28 bitop3:0xf6
    v_bitop3_b32 v5, v5, v71, s28 bitop3:0xf6
    v_bitop3_b32 v5, v5, v73, s28 bitop3:0xf6
    v_bitop3_b32 v5, v5, v75, s28 bitop3:0xf6
    v_bitop3_b32 v5, v5, v77, s28 bitop3:0xf6
    v_bitop3_b32 v5, v5, v79, s28 bitop3:0xf6
    v_bitop3_b32 v5, v5, v81, s28 bitop3:0xf6
    v_bitop3_b32 v5, v5, v83, s28 bitop3:0xf6
    v_bitop3_b32 v5, v5, v85, s28 bitop3:0xf6
    v_bitop3_b32 v5, v5, v87, s28 bitop3:0xf6
    v_bitop3_b32 v5, v5, v89, s28 bitop3:0xf6
    v_bitop3_b32 v5, v5, v91, s28 bitop3:0xf6
    v_bitop3_b32 v5, v5, v93, s28 bitop3:0xf6
    v_bitop3_b32 v5, v5, v95, s28 bitop3:0xf6
    v_bitop3_b32 v5, v5, v97, s28 bitop3:0xf6
    v_bitop3_b32 v5, v5, v99, s28 bitop3:0xf6
    v_bitop3_b32 v5, v5, v101, s28 bitop3:0xf6
    v_bitop3_b32 v5, v5, v103, s28 bitop3:0xf6
    v_bitop3_b32 v5, v5, v105, s28 bitop3:0xf6
    v_bitop3_b32 v5, v5, v107, s28 bitop3:0xf6
    v_bitop3_b32 v5, v5, v109, s28 bitop3:0xf6
    v_bitop3_b32 v5, v5, v111, s28 bitop3:0xf6
    v_bitop3_b32 v5, v5, v113, s28 bitop3:0xf6
    v_bitop3_b32 v5, v5, v115, s28 bitop3:0xf6
    v_bitop3_b32 v5, v5, v117, s28 bitop3:0xf6
    v_bitop3_b32 v5, v5, v119, s28 bitop3:0xf6
    v_bitop3_b32 v5, v5, v121, s28 bitop3:0xf6
    v_bitop3_b32 v5, v5, v123, s28 bitop3:0xf6
    v_bitop3_b32 v5, v5, v125, s28 bitop3:0xf6
    v_bitop3_b32 v5, v5, v127, s28 bitop3:0xf6
    v_cmp_ne_u32 vcc, 0, v5
    s_cbranch_vccz L_f_keysok
    s_sub_u32 s29, s29, 1
    s_cbranch_scc1 L_end
    s_branch L_f_keys
L_f_keysok:
    s_cmp_lg_u32 s2, 0
    s_cbranch_scc1 L_f_noepoch
    s_mov_b64 exec, 1
    buffer_store_dword v9, off, s[36:39], 0 offset:0 sc1
    s_mov_b64 exec, -1
L_f_noepoch:
    v_max_u32 v16, v64, v66
    v_max3_u32 v16, v16, v68, v70
    v_max3_u32 v16, v16, v72, v74
    v_max3_u32 v16, v16, v76, v78
    v_max3_u32 v16, v16, v80, v82
    v_max3_u32 v16, v16, v84, v86
    v_max3_u32 v16, v16, v88, v90
    v_max3_u32 v16, v16, v92, v94
    v_max3_u32 v16, v16, v96, v98
    v_max3_u32 v16, v16, v100, v102
    v_max3_u32 v16, v16, v104, v106
    v_max3_u32 v16, v16, v108, v110
    v_max3_u32 v16, v16, v112, v114
    v_max3_u32 v16, v16, v116, v118
    v_max3_u32 v16, v16, v120, v122
    v_max3_u32 v16, v16, v124, v126
    v_mov_b32 v17, v16
    s_waitcnt lgkmcnt(0)
    s_barrier
    v_max_u32_dpp v18, v17, v17 quad_perm:[1,0,3,2] row_mask:0xf bank_mask:0xf
    s_nop 1
    v_max_u32_dpp v18, v18, v18 quad_perm:[2,3,0,1] row_mask:0xf bank_mask:0xf
    s_nop 1
    v_max_u32_dpp v18, v18, v18 row_half_mirror row_mask:0xf bank_mask:0xf
    s_nop 1
    v_max_u32_dpp v18, v18, v18 row_mirror row_mask:0xf bank_mask:0xf
    s_nop 0
    v_readlane_b32 s48, v18, 0
    v_readlane_b32 s49, v18, 16
    v_readlane_b32 s50, v18, 32
    v_readlane_b32 s51, v18, 48
    s_max_u32 s48, s48, s49
    s_max_u32 s50, s50, s51
    s_max_u32 s60, s48, s50
    v_cmp_ne_u32 vcc, s60, v17
    s_nop 1
    v_cndmask_b32_e64 v17, 0, v17, vcc
    ds_read_b64_tr_b16 v[128:129], v12 offset:0
    ds_read_b64_tr_b16 v[130:131], v12 offset:512
    ds_read_b64_tr_b16 v[132:133], v13 offset:0
    ds_read_b64_tr_b16 v[134:135], v13 offset:512
    ds_read_b64_tr_b16 v[136:137], v14 offset:0
    ds_read_b64_tr_b16 v[138:139], v14 offset:512
    ds_read_b64_tr_b16 v[140:141], v15 offset:0
    ds_read_b64_tr_b16 v[142:143], v15 offset:512
    v_max_u32_dpp v18, v17, v17 quad_perm:[1,0,3,2] row_mask:0xf bank_mask:0xf
    s_nop 1
    v_max_u32_dpp v18, v18, v18 quad_perm:[2,3,0,1] row_mask:0xf bank_mask:0xf
    s_nop 1
    v_max_u32_dpp v18, v18, v18 row_half_mirror row_mask:0xf bank_mask:0xf
    s_nop 1
    v_max_u32_dpp v18, v18, v18 row_mirror row_mask:0xf bank_mask:0xf
    s_nop 0
    v_readlane_b32 s48, v18, 0
    v_readlane_b32 s49, v18, 16
    v_readlane_b32 s50, v18, 32
    v_readlane_b32 s51, v18, 48
    s_max_u32 s48, s48, s49
    s_max_u32 s50, s50, s51
    s_max_u32 s61, s48, s50
    v_cmp_ne_u32 vcc, s61, v17
    s_nop 1
    v_cndmask_b32 v17, 0, v17, vcc
    ds_read_b64_tr_b16 v[144:145], v12 offset:4096
    ds_read_b64_tr_b16 v[146:147], v12 offset:4608
    ds_read_b64_tr_b16 v[148:149], v13 offset:4096
    ds_read_b64_tr_b16 v[150:151], v13 offset:4608
    ds_read_b64_tr_b16 v[152:153], v14 offset:4096
    ds_read_b64_tr_b16 v[154:155], v14 offset:4608
    ds_read_b64_tr_b16 v[156:157], v15 offset:4096
    ds_read_b64_tr_b16 v[158:159], v15 offset:4608
    s_waitcnt lgkmcnt(0)
    s_barrier
    v_max_u32_dpp v18, v17, v17 quad_perm:[1,0,3,2] row_mask:0xf bank_mask:0xf
    s_nop 1
    v_max_u32_dpp v18, v18, v18 quad_perm:[2,3,0,1] row_mask:0xf bank_mask:0xf
    s_nop 1
    v_max_u32_dpp v18, v18, v18 row_half_mirror row_mask:0xf bank_mask:0xf
    s_nop 1
    v_max_u32_dpp v18, v18, v18 row_mirror row_mask:0xf bank_mask:0xf
    s_nop 0
    v_readlane_b32 s48, v18, 0
    v_readlane_b32 s49, v18, 16
    v_readlane_b32 s50, v18, 32
    v_readlane_b32 s51, v18, 48
    s_max_u32 s48, s48, s49
    s_max_u32 s50, s50, s51
    s_max_u32 s62, s48, s50
    v_cmp_ne_u32 vcc, s62, v17
    s_nop 1
    v_cndmask_b32 v17, 0, v17, vcc
    s_nop 1
    v_max_u32_dpp v18, v17, v17 quad_perm:[1,0,3,2] row_mask:0xf bank_mask:0xf
    s_nop 1
    v_max_u32_dpp v18, v18, v18 quad_perm:[2,3,0,1] row_mask:0xf bank_mask:0xf
    s_nop 1
    v_max_u32_dpp v18, v18, v18 row_half_mirror row_mask:0xf bank_mask:0xf
    s_nop 1
    v_max_u32_dpp v18, v18, v18 row_mirror row_mask:0xf bank_mask:0xf
    s_nop 0
    v_readlane_b32 s48, v18, 0
    v_readlane_b32 s49, v18, 16
    v_readlane_b32 s50, v18, 32
    v_readlane_b32 s51, v18, 48
    s_max_u32 s48, s48, s49
    s_max_u32 s50, s50, s51
    s_max_u32 s63, s48, s50
    v_cmp_ne_u32 vcc, s63, v17
    s_nop 1
    v_cndmask_b32 v17, 0, v17, vcc
    s_nop 1
    v_max_u32_dpp v18, v17, v17 quad_perm:[1,0,3,2] row_mask:0xf bank_mask:0xf
    s_nop 1
    v_max_u32_dpp v18, v18, v18 quad_perm:[2,3,0,1] row_mask:0xf bank_mask:0xf
    s_nop 1
    v_max_u32_dpp v18, v18, v18 row_half_mirror row_mask:0xf bank_mask:0xf
    s_nop 1
    v_max_u32_dpp v18, v18, v18 row_mirror row_mask:0xf bank_mask:0xf
    s_nop 0
    v_readlane_b32 s48, v18, 0
    v_readlane_b32 s49, v18, 16
    v_readlane_b32 s50, v18, 32
    v_readlane_b32 s51, v18, 48
    s_max_u32 s48, s48, s49
    s_max_u32 s50, s50, s51
    s_max_u32 s64, s48, s50
    v_cmp_ne_u32 vcc, s64, v17
    s_nop 1
    v_cndmask_b32 v17, 0, v17, vcc
    s_nop 1
    v_max_u32_dpp v18, v17, v17 quad_perm:[1,0,3,2] row_mask:0xf bank_mask:0xf
    s_nop 1
    v_max_u32_dpp v18, v18, v18 quad_perm:[2,3,0,1] row_mask:0xf bank_mask:0xf
    s_nop 1
    v_max_u32_dpp v18, v18, v18 row_half_mirror row_mask:0xf bank_mask:0xf
    s_nop 1
    v_max_u32_dpp v18, v18, v18 row_mirror row_mask:0xf bank_mask:0xf
    s_nop 0
    v_readlane_b32 s48, v18, 0
    v_readlane_b32 s49, v18, 16
    v_readlane_b32 s50, v18, 32
    v_readlane_b32 s51, v18, 48
    s_max_u32 s48, s48, s49
    s_max_u32 s50, s50, s51
    s_max_u32 s65, s48, s50
    v_cmp_ne_u32 vcc, s65, v17
    s_nop 1
    v_cndmask_b32 v17, 0, v17, vcc
    s_waitcnt lgkmcnt(0)
    s_barrier
    v_max_u32_dpp v18, v17, v17 quad_perm:[1,0,3,2] row_mask:0xf bank_mask:0xf
    s_nop 1
    v_max_u32_dpp v18, v18, v18 quad_perm:[2,3,0,1] row_mask:0xf bank_mask:0xf
    s_nop 1
    v_max_u32_dpp v18, v18, v18 row_half_mirror row_mask:0xf bank_mask:0xf
    s_nop 1
    v_max_u32_dpp v18, v18, v18 row_mirror row_mask:0xf bank_mask:0xf
    s_nop 0
    v_readlane_b32 s48, v18, 0
    v_readlane_b32 s49, v18, 16
    v_readlane_b32 s50, v18, 32
    v_readlane_b32 s51, v18, 48
    s_max_u32 s48, s48, s49
    s_max_u32 s50, s50, s51
    s_max_u32 s66, s48, s50
    v_cmp_ne_u32 vcc, s66, v17
    s_nop 1
    v_cndmask_b32_e64 v17, 0, v17, vcc
    ds_read_b64_tr_b16 v[160:161], v12 offset:8192
    ds_read_b64_tr_b16 v[162:163], v12 offset:8704
    ds_read_b64_tr_b16 v[164:165], v13 offset:8192
    ds_read_b64_tr_b16 v[166:167], v13 offset:8704
    ds_read_b64_tr_b16 v[168:169], v14 offset:8192
    ds_read_b64_tr_b16 v[170:171], v14 offset:8704
    ds_read_b64_tr_b16 v[172:173], v15 offset:8192
    ds_read_b64_tr_b16 v[174:175], v15 offset:8704
    v_max_u32_dpp v18, v17, v17 quad_perm:[1,0,3,2] row_mask:0xf bank_mask:0xf
    s_nop 1
    v_max_u32_dpp v18, v18, v18 quad_perm:[2,3,0,1] row_mask:0xf bank_mask:0xf
    s_nop 1
    v_max_u32_dpp v18, v18, v18 row_half_mirror row_mask:0xf bank_mask:0xf
    s_nop 1
    v_max_u32_dpp v18, v18, v18 row_mirror row_mask:0xf bank_mask:0xf
    s_nop 0
    v_readlane_b32 s48, v18, 0
    v_readlane_b32 s49, v18, 16
    v_readlane_b32 s50, v18, 32
    v_readlane_b32 s51, v18, 48
    s_max_u32 s48, s48, s49
    s_max_u32 s50, s50, s51
    s_max_u32 s67, s48, s50
    ds_read_b64_tr_b16 v[176:177], v12 offset:12288
    ds_read_b64_tr_b16 v[178:179], v12 offset:12800
    ds_read_b64_tr_b16 v[180:181], v13 offset:12288
    ds_read_b64_tr_b16 v[182:183], v13 offset:12800
    ds_read_b64_tr_b16 v[184:185], v14 offset:12288
    ds_read_b64_tr_b16 v[186:187], v14 offset:12800
    ds_read_b64_tr_b16 v[188:189], v15 offset:12288
    ds_read_b64_tr_b16 v[190:191], v15 offset:12800
    s_waitcnt lgkmcnt(0)
    s_barrier
    s_mov_b32 s52, 7
L_f_round:
    v_subrev_u32 v16, 1, v16
    v_sub_u32 v65, v16, v64
    v_sub_u32 v67, v16, v66
    v_sub_u32 v69, v16, v68
    v_sub_u32 v71, v16, v70
    v_sub_u32 v73, v16, v72
    v_sub_u32 v75, v16, v74
    v_sub_u32 v77, v16, v76
    v_sub_u32 v79, v16, v78
    v_sub_u32 v81, v16, v80
    v_sub_u32 v83, v16, v82
    v_sub_u32 v85, v16, v84
    v_sub_u32 v87, v16, v86
    v_sub_u32 v89, v16, v88
    v_sub_u32 v91, v16, v90
    v_sub_u32 v93, v16, v92
    v_sub_u32 v95, v16, v94
    v_sub_u32 v97, v16, v96
    v_sub_u32 v99, v16, v98
    v_sub_u32 v101, v16, v100
    v_sub_u32 v103, v16, v102
    v_sub_u32 v105, v16, v104
    v_sub_u32 v107, v16, v106
    v_sub_u32 v109, v16, v108
    v_sub_u32 v111, v16, v110
    v_sub_u32 v113, v16, v112
    v_sub_u32 v115, v16, v114
    v_sub_u32 v117, v16, v116
    v_sub_u32 v119, v16, v118
    v_sub_u32 v121, v16, v120
    v_sub_u32 v123, v16, v122
    v_sub_u32 v125, v16, v124
    v_sub_u32 v127, v16, v126
    v_min_u32 v17, v65, v67
    v_min3_u32 v17, v17, v69, v71
    v_min3_u32 v17, v17, v73, v75
    v_min3_u32 v17, v17, v77, v79
    v_min3_u32 v17, v17, v81, v83
    v_min3_u32 v17, v17, v85, v87
    v_min3_u32 v17, v17, v89, v91
    v_min3_u32 v17, v17, v93, v95
    v_min3_u32 v17, v17, v97, v99
    v_min3_u32 v17, v17, v101, v103
    v_min3_u32 v17, v17, v105, v107
    v_min3_u32 v17, v17, v109, v111
    v_min3_u32 v17, v17, v113, v115
    v_min3_u32 v17, v17, v117, v119
    v_min3_u32 v17, v17, v121, v123
    v_min3_u32 v17, v17, v125, v127
    v_sub_u32 v16, v16, v17
    v_cmp_le_u32 vcc, s67, v16
    s_cbranch_vccz L_f_seldone
L_f_ins:
    s_ff1_i32_b64 s49, vcc
    s_bitset0_b64 vcc, s49
    v_readlane_b32 s50, v16, s49
    s_min_u32 s51, s60, s50
    s_max_u32 s60, s60, s50
    s_min_u32 s50, s61, s51
    s_max_u32 s61, s61, s51
    s_min_u32 s51, s62, s50
    s_max_u32 s62, s62, s50
    s_min_u32 s50, s63, s51
    s_max_u32 s63, s63, s51
    s_min_u32 s51, s64, s50
    s_max_u32 s64, s64, s50
    s_min_u32 s50, s65, s51
    s_max_u32 s65, s65, s51
    s_min_u32 s51, s66, s50
    s_max_u32 s66, s66, s50
    s_min_u32 s50, s67, s51
    s_max_u32 s67, s67, s51
    s_cmp_lg_u64 vcc, 0
    s_cbranch_scc1 L_f_ins
    s_sub_u32 s52, s52, 1
    s_cmp_lg_u32 s52, 0
    s_cbranch_scc1 L_f_round
L_f_seldone:
    v_mov_b32_e64 v5, s60
    v_writelane_b32 v5, s61, 1
    v_writelane_b32 v5, s62, 2
    v_writelane_b32 v5, s63, 3
    v_writelane_b32 v5, s64, 4
    v_writelane_b32 v5, s65, 5
    v_writelane_b32 v5, s66, 6
    v_writelane_b32 v5, s67, 7
    v_lshlrev_b32 v16, 2, v0
    s_mov_b64 exec, 0xff
    ds_write_b32 v16, v5 offset:1408
    s_mov_b64 exec, -1
    s_branch L_f_join
L_f1:
    buffer_load_dwordx2 v[20:21], v16, s[36:39], s55 offen sc1
    buffer_load_dwordx2 v[22:23], v17, s[36:39], s55 offen sc1
    buffer_load_dwordx2 v[24:25], v18, s[36:39], s55 offen sc1
    s_cmp_lg_u32 s53, 0
    s_cbranch_scc1 L_f1_poll2
    s_barrier
L_f1_poll2:
    s_waitcnt vmcnt(0)
    s_mov_b32 s53, 1
    v_xor_b32 v5, s28, v21
    v_bitop3_b32 v5, v5, v23, s28 bitop3:0xf6
    v_bitop3_b32 v5, v5, v25, s28 bitop3:0xf6
    v_cmp_ne_u32 vcc, 0, v5
    s_cbranch_vccz L_f1_ok
    s_sub_u32 s29, s29, 1
    s_cbranch_scc1 L_end
    s_branch L_f1
L_f1_ok:
    v_lshlrev_b32 v21, 16, v20
    v_and_b32 v20, 0xffff0000, v20
    v_rcp_f32 v21, v21
    v_lshlrev_b32 v23, 16, v22
    v_and_b32 v22, 0xffff0000, v22
    v_rcp_f32 v23, v23
    v_lshlrev_b32 v25, 16, v24
    v_and_b32 v24, 0xffff0000, v24
    v_rcp_f32 v25, v25
    v_lshlrev_b32 v16, 2, v0
    v_lshlrev_b32 v19, 2, v19
    s_waitcnt lgkmcnt(0)
    s_barrier
    ds_read_b64_tr_b16 v[128:129], v12 offset:0
    ds_read_b64_tr_b16 v[130:131], v12 offset:512
    ds_read_b64_tr_b16 v[132:133], v13 offset:0
    ds_read_b64_tr_b16 v[134:135], v13 offset:512
    ds_read_b64_tr_b16 v[136:137], v14 offset:0
    ds_read_b64_tr_b16 v[138:139], v14 offset:512
    ds_read_b64_tr_b16 v[140:141], v15 offset:0
    ds_read_b64_tr_b16 v[142:143], v15 offset:512
    ds_read_b64_tr_b16 v[144:145], v12 offset:4096
    ds_read_b64_tr_b16 v[146:147], v12 offset:4608
    ds_read_b64_tr_b16 v[148:149], v13 offset:4096
    ds_read_b64_tr_b16 v[150:151], v13 offset:4608
    ds_read_b64_tr_b16 v[152:153], v14 offset:4096
    ds_read_b64_tr_b16 v[154:155], v14 offset:4608
    ds_read_b64_tr_b16 v[156:157], v15 offset:4096
    ds_read_b64_tr_b16 v[158:159], v15 offset:4608
    s_waitcnt lgkmcnt(0)
    s_barrier
    ds_write_b32 v16, v20 offset:256
    ds_write_b32 v16, v22 offset:512
    ds_write_b32 v19, v24 offset:768
    ds_write_b32 v16, v21 offset:832
    ds_write_b32 v16, v23 offset:1088
    ds_write_b32 v19, v25 offset:1344
    s_waitcnt lgkmcnt(0)
    s_barrier
    ds_read_b64_tr_b16 v[160:161], v12 offset:8192
    ds_read_b64_tr_b16 v[162:163], v12 offset:8704
    ds_read_b64_tr_b16 v[164:165], v13 offset:8192
    ds_read_b64_tr_b16 v[166:167], v13 offset:8704
    ds_read_b64_tr_b16 v[168:169], v14 offset:8192
    ds_read_b64_tr_b16 v[170:171], v14 offset:8704
    ds_read_b64_tr_b16 v[172:173], v15 offset:8192
    ds_read_b64_tr_b16 v[174:175], v15 offset:8704
    ds_read_b64_tr_b16 v[176:177], v12 offset:12288
    ds_read_b64_tr_b16 v[178:179], v12 offset:12800
    ds_read_b64_tr_b16 v[180:181], v13 offset:12288
    ds_read_b64_tr_b16 v[182:183], v13 offset:12800
    ds_read_b64_tr_b16 v[184:185], v14 offset:12288
    ds_read_b64_tr_b16 v[186:187], v14 offset:12800
    ds_read_b64_tr_b16 v[188:189], v15 offset:12288
    ds_read_b64_tr_b16 v[190:191], v15 offset:12800
    s_waitcnt lgkmcnt(0)
    s_barrier
L_f_join:
    s_and_b32 s60, s28, 0xff
    s_bfe_u32 s61, s28, 0x80008
    s_bfe_u32 s62, s28, 0x80010
    s_lshr_b32 s63, s28, 24
    s_cmp_eq_u32 s69, 0
    s_cbranch_scc1 L_f_idle
    s_waitcnt lgkmcnt(0)
    s_barrier
    v_lshlrev_b32 v5, 2, v6
    v_lshrrev_b32 v10, 3, v0
    v_lshlrev_b32 v8, 2, v10
    v_xor_b32 v10, v10, v6
    s_lshl_b32 s48, s57, 9
    v_mov_b32 v11, s28
    v_xor_b32 v16, v7, v6
    v_lshlrev_b32 v16, 4, v16
    v_lshl_add_u32 v17, v6, 7, s59
    v_and_b32 v18, 8, v0
    v_cmp_eq_u32 vcc, 0, v18
    v_mov_b32 v18, 1024
    s_nop 0
    v_cndmask_b32 v17, 0, v17, vcc
    v_cndmask_b32 v18, 0, v18, vcc
    v_add_u32 v16, v16, v17
    v_xor_b32 v17, 64, v16
    ds_read_b32 v5, v5 offset:1408
    ds_read_b32 v8, v8 offset:1408
    ds_read_b64_tr_b16 v[192:193], v12 offset:0
    ds_read_b64_tr_b16 v[194:195], v12 offset:512
    ds_read_b64_tr_b16 v[196:197], v13 offset:0
    ds_read_b64_tr_b16 v[198:199], v13 offset:512
    ds_read_b64_tr_b16 v[200:201], v14 offset:0
    ds_read_b64_tr_b16 v[202:203], v14 offset:512
    ds_read_b64_tr_b16 v[204:205], v15 offset:0
    ds_read_b64_tr_b16 v[206:207], v15 offset:512
    s_waitcnt lgkmcnt(8)
    v_not_b32 v5, v5
    v_and_b32 v5, 0x7ff, v5
    v_not_b32 v8, v8
    v_and_b32 v8, 0x7ff, v8
    v_lshlrev_b32 v8, 11, v8
    v_lshl_add_u32 v8, v10, 4, v8
    v_lshlrev_b32 v9, 3, v5
    s_waitcnt lgkmcnt(0)
    s_add_u32 m0, s59, 0
    s_nop 0
    buffer_load_dwordx4 v8, s[32:35], s48 offen offset:0 lds
    s_add_u32 m0, s59, 896
    s_nop 0
    buffer_load_dwordx4 v8, s[32:35], s48 offen offset:128 lds
    s_add_u32 m0, s59, 1792
    s_nop 0
    buffer_load_dwordx4 v8, s[32:35], s48 offen offset:256 lds
    s_add_u32 m0, s59, 2688
    s_nop 0
    buffer_load_dwordx4 v8, s[32:35], s48 offen offset:384 lds
    s_mov_b32 exec_lo, 0x00ff00ff
    s_mov_b32 exec_hi, 0x00ff00ff
    buffer_load_dwordx2 v[10:11], v9, s[36:39], s55 offen sc1
    s_mov_b64 exec, -1
    ds_read_b64_tr_b16 v[208:209], v12 offset:4096
    ds_read_b64_tr_b16 v[210:211], v12 offset:4608
    ds_read_b64_tr_b16 v[212:213], v13 offset:4096
    ds_read_b64_tr_b16 v[214:215], v13 offset:4608
    ds_read_b64_tr_b16 v[216:217], v14 offset:4096
    ds_read_b64_tr_b16 v[218:219], v14 offset:4608
    ds_read_b64_tr_b16 v[220:221], v15 offset:4096
    ds_read_b64_tr_b16 v[222:223], v15 offset:4608
    s_waitcnt lgkmcnt(0)
    s_barrier
    s_waitcnt vmcnt(0)
    ds_read_b128 v[32:35], v16
    ds_read_b128 v[36:39], v17
    v_add_u32 v16, v16, v18
    v_add_u32 v17, v17, v18
    ds_read_b128 v[40:43], v16
    ds_read_b128 v[44:47], v17
    v_add_u32 v16, v16, v18
    v_add_u32 v17, v17, v18
    ds_read_b128 v[48:51], v16
    ds_read_b128 v[52:55], v17
    v_add_u32 v16, v16, v18
    v_add_u32 v17, v17, v18
    ds_read_b128 v[56:59], v16
    ds_read_b128 v[60:63], v17
L_f_sst:
    v_cmp_ne_u32 vcc, s28, v11
    s_cbranch_vccz L_f_sstok
    s_sub_u32 s29, s29, 1
    s_cbranch_scc1 L_end
    buffer_load_dwordx2 v[10:11], v9, s[36:39], s55 offen sc1
    s_waitcnt vmcnt(0)
    s_branch L_f_sst
L_f_sstok:
    v_lshlrev_b32 v11, 16, v10
    v_and_b32 v10, 0xffff0000, v10
    v_rcp_f32 v11, v11
    v_xor_b32 v10, 0x80000000, v10
    v_mov_b32 v9, 0xffffff00
    v_lshl_add_u32 v8, v7, 3, v6
    v_lshlrev_b32 v8, 4, v8
    s_and_b32 s48, s3, 1
    s_lshl_b32 s48, s48, 2
    s_xor_b32 s48, s48, s58
    s_lshl_b32 s48, s48, 1
    s_add_u32 s48, s48, s3
    s_lshl_b32 s48, s48, 11
    s_add_u32 s48, s48, 1048576
    s_waitcnt lgkmcnt(0)
    s_barrier
    ds_read_b64_tr_b16 v[224:225], v12 offset:8192
    ds_read_b64_tr_b16 v[226:227], v12 offset:8704
    ds_read_b64_tr_b16 v[228:229], v13 offset:8192
    ds_read_b64_tr_b16 v[230:231], v13 offset:8704
    ds_read_b64_tr_b16 v[232:233], v14 offset:8192
    ds_read_b64_tr_b16 v[234:235], v14 offset:8704
    ds_read_b64_tr_b16 v[236:237], v15 offset:8192
    ds_read_b64_tr_b16 v[238:239], v15 offset:8704
    s_sleep 3
    s_add_u32 m0, s59, 0
    s_add_u32 s50, s54, 0
    s_nop 0
    buffer_load_dwordx4 v2, s[44:47], s50 offen nt lds
    s_add_u32 m0, s59, 1024
    s_add_u32 s50, s54, 16384
    buffer_load_dwordx4 v2, s[44:47], s50 offen nt lds
    s_add_u32 m0, s59, 2048
    s_add_u32 s50, s54, 32768
    buffer_load_dwordx4 v2, s[44:47], s50 offen nt lds
    s_add_u32 m0, s59, 3072
    s_add_u32 s50, s54, 49152
    buffer_load_dwordx4 v2, s[44:47], s50 offen nt lds
    s_add_u32 m0, s59, 4096
    s_add_u32 s50, s54, 65536
    buffer_load_dwordx4 v2, s[44:47], s50 offen nt lds
    s_add_u32 m0, s59, 5120
    s_add_u32 s50, s54, 81920
    buffer_load_dwordx4 v2, s[44:47], s50 offen nt lds
    s_add_u32 m0, s59, 6144
    s_add_u32 s50, s54, 98304
    buffer_load_dwordx4 v2, s[44:47], s50 offen nt lds
    s_add_u32 m0, s59, 7168
    s_add_u32 s50, s54, 114688
    buffer_load_dwordx4 v2, s[44:47], s50 offen nt lds
    ds_read_b64_tr_b16 v[240:241], v12 offset:12288
    ds_read_b64_tr_b16 v[242:243], v12 offset:12800
    ds_read_b64_tr_b16 v[244:245], v13 offset:12288
    ds_read_b64_tr_b16 v[246:247], v13 offset:12800
    ds_read_b64_tr_b16 v[248:249], v14 offset:12288
    ds_read_b64_tr_b16 v[250:251], v14 offset:12800
    ds_read_b64_tr_b16 v[252:253], v15 offset:12288
    ds_read_b64_tr_b16 v[254:255], v15 offset:12800
    s_waitcnt lgkmcnt(0)
    s_barrier
    s_setprio 3
    v_mfma_f32_16x16x32_bf16 v[16:19], v[128:131], v[32:35], 0
    v_mfma_f32_16x16x32_bf16 v[20:23], v[132:135], v[32:35], 0
    v_mfma_f32_16x16x32_bf16 v[24:27], v[136:139], v[32:35], 0
    v_mfma_f32_16x16x32_bf16 v[28:31], v[140:143], v[32:35], 0
    v_mfma_f32_16x16x32_bf16 v[16:19], v[144:147], v[36:39], v[16:19]
    v_mfma_f32_16x16x32_bf16 v[20:23], v[148:151], v[36:39], v[20:23]
    v_mfma_f32_16x16x32_bf16 v[24:27], v[152:155], v[36:39], v[24:27]
    v_mfma_f32_16x16x32_bf16 v[28:31], v[156:159], v[36:39], v[28:31]
    v_mfma_f32_16x16x32_bf16 v[16:19], v[160:163], v[40:43], v[16:19]
    v_mfma_f32_16x16x32_bf16 v[20:23], v[164:167], v[40:43], v[20:23]
    v_mfma_f32_16x16x32_bf16 v[24:27], v[168:171], v[40:43], v[24:27]
    v_mfma_f32_16x16x32_bf16 v[28:31], v[172:175], v[40:43], v[28:31]
    v_mfma_f32_16x16x32_bf16 v[16:19], v[176:179], v[44:47], v[16:19]
    v_mfma_f32_16x16x32_bf16 v[20:23], v[180:183], v[44:47], v[20:23]
    v_mfma_f32_16x16x32_bf16 v[24:27], v[184:187], v[44:47], v[24:27]
    v_mfma_f32_16x16x32_bf16 v[28:31], v[188:191], v[44:47], v[28:31]
    v_mfma_f32_16x16x32_bf16 v[16:19], v[192:195], v[48:51], v[16:19]
    v_mfma_f32_16x16x32_bf16 v[20:23], v[196:199], v[48:51], v[20:23]
    v_mfma_f32_16x16x32_bf16 v[24:27], v[200:203], v[48:51], v[24:27]
    v_mfma_f32_16x16x32_bf16 v[28:31], v[204:207], v[48:51], v[28:31]
    v_mfma_f32_16x16x32_bf16 v[16:19], v[208:211], v[52:55], v[16:19]
    v_mfma_f32_16x16x32_bf16 v[20:23], v[212:215], v[52:55], v[20:23]
    v_mfma_f32_16x16x32_bf16 v[24:27], v[216:219], v[52:55], v[24:27]
    v_mfma_f32_16x16x32_bf16 v[28:31], v[220:223], v[52:55], v[28:31]
    v_mfma_f32_16x16x32_bf16 v[16:19], v[224:227], v[56:59], v[16:19]
    v_mfma_f32_16x16x32_bf16 v[20:23], v[228:231], v[56:59], v[20:23]
    v_mfma_f32_16x16x32_bf16 v[24:27], v[232:235], v[56:59], v[24:27]
    v_mfma_f32_16x16x32_bf16 v[28:31], v[236:239], v[56:59], v[28:31]
    v_mfma_f32_16x16x32_bf16 v[16:19], v[240:243], v[60:63], v[16:19]
    v_mfma_f32_16x16x32_bf16 v[20:23], v[244:247], v[60:63], v[20:23]
    v_mfma_f32_16x16x32_bf16 v[24:27], v[248:251], v[60:63], v[24:27]
    v_mfma_f32_16x16x32_bf16 v[28:31], v[252:255], v[60:63], v[28:31]
    s_setprio 0
    v_lshrrev_b32 v12, 2, v0
    v_lshlrev_b32 v12, 7, v12
    v_and_b32 v13, 3, v0
    v_lshl_add_u32 v12, v13, 3, v12
    v_bfe_u32 v13, v0, 3, 2
    v_lshl_add_u32 v12, v13, 5, v12
    v_add_u32 v12, s59, v12
    v_xor_b32 v13, 32, v12
    v_xor_b32 v14, 64, v12
    v_xor_b32 v15, 96, v12
    v_fmac_f32_dpp v16, v16, v10 row_newbcast:8 row_mask:0xf bank_mask:0xf
    v_fmac_f32_dpp v17, v17, v10 row_newbcast:8 row_mask:0xf bank_mask:0xf
    v_fmac_f32_dpp v18, v18, v10 row_newbcast:8 row_mask:0xf bank_mask:0xf
    v_fmac_f32_dpp v19, v19, v10 row_newbcast:8 row_mask:0xf bank_mask:0xf
    v_fmac_f32_dpp v20, v20, v10 row_newbcast:8 row_mask:0xf bank_mask:0xf
    v_fmac_f32_dpp v21, v21, v10 row_newbcast:8 row_mask:0xf bank_mask:0xf
    v_fmac_f32_dpp v22, v22, v10 row_newbcast:8 row_mask:0xf bank_mask:0xf
    v_fmac_f32_dpp v23, v23, v10 row_newbcast:8 row_mask:0xf bank_mask:0xf
    v_fmac_f32_dpp v24, v24, v10 row_newbcast:8 row_mask:0xf bank_mask:0xf
    v_fmac_f32_dpp v25, v25, v10 row_newbcast:8 row_mask:0xf bank_mask:0xf
    v_fmac_f32_dpp v26, v26, v10 row_newbcast:8 row_mask:0xf bank_mask:0xf
    v_fmac_f32_dpp v27, v27, v10 row_newbcast:8 row_mask:0xf bank_mask:0xf
    v_fmac_f32_dpp v28, v28, v10 row_newbcast:8 row_mask:0xf bank_mask:0xf
    v_fmac_f32_dpp v29, v29, v10 row_newbcast:8 row_mask:0xf bank_mask:0xf
    v_fmac_f32_dpp v30, v30, v10 row_newbcast:8 row_mask:0xf bank_mask:0xf
    v_fmac_f32_dpp v31, v31, v10 row_newbcast:8 row_mask:0xf bank_mask:0xf
    v_mul_f32 v16, v16, v11
    v_mul_f32 v17, v17, v11
    v_mul_f32 v18, v18, v11
    v_mul_f32 v19, v19, v11
    v_mul_f32 v20, v20, v11
    v_mul_f32 v21, v21, v11
    v_mul_f32 v22, v22, v11
    v_mul_f32 v23, v23, v11
    v_mul_f32 v24, v24, v11
    v_mul_f32 v25, v25, v11
    v_mul_f32 v26, v26, v11
    v_mul_f32 v27, v27, v11
    v_mul_f32 v28, v28, v11
    v_mul_f32 v29, v29, v11
    v_mul_f32 v30, v30, v11
    v_mul_f32 v31, v31, v11
    v_and_or_b32 v16, v16, v9, s60
    v_and_or_b32 v17, v17, v9, s61
    v_and_or_b32 v18, v18, v9, s62
    v_and_or_b32 v19, v19, v9, s63
    v_and_or_b32 v20, v20, v9, s60
    v_and_or_b32 v21, v21, v9, s61
    v_and_or_b32 v22, v22, v9, s62
    v_and_or_b32 v23, v23, v9, s63
    v_and_or_b32 v24, v24, v9, s60
    v_and_or_b32 v25, v25, v9, s61
    v_and_or_b32 v26, v26, v9, s62
    v_and_or_b32 v27, v27, v9, s63
    v_and_or_b32 v28, v28, v9, s60
    v_and_or_b32 v29, v29, v9, s61
    v_and_or_b32 v30, v30, v9, s62
    v_and_or_b32 v31, v31, v9, s63
    s_mov_b32 exec_lo, 0x00ff00ff
    s_mov_b32 exec_hi, 0x00ff00ff
    buffer_store_dwordx4 v[16:19], v8, s[36:39], s48 offen offset:0 sc1
    buffer_store_dwordx4 v[20:23], v8, s[36:39], s48 offen offset:512 sc1
    buffer_store_dwordx4 v[24:27], v8, s[36:39], s48 offen offset:1024 sc1
    buffer_store_dwordx4 v[28:31], v8, s[36:39], s48 offen offset:1536 sc1
    s_mov_b64 exec, -1
    s_nop 0
    s_add_u32 m0, s59, 8192
    s_add_u32 s50, s54, 128
    buffer_load_dwordx4 v2, s[44:47], s50 offen nt lds
    s_add_u32 m0, s59, 9216
    s_add_u32 s50, s54, 16512
    buffer_load_dwordx4 v2, s[44:47], s50 offen nt lds
    s_add_u32 m0, s59, 10240
    s_add_u32 s50, s54, 32896
    buffer_load_dwordx4 v2, s[44:47], s50 offen nt lds
    s_add_u32 m0, s59, 11264
    s_add_u32 s50, s54, 49280
    buffer_load_dwordx4 v2, s[44:47], s50 offen nt lds
    s_add_u32 m0, s59, 12288
    s_add_u32 s50, s54, 65664
    buffer_load_dwordx4 v2, s[44:47], s50 offen nt lds
    s_add_u32 m0, s59, 13312
    s_add_u32 s50, s54, 82048
    buffer_load_dwordx4 v2, s[44:47], s50 offen nt lds
    s_add_u32 m0, s59, 14336
    s_add_u32 s50, s54, 98432
    buffer_load_dwordx4 v2, s[44:47], s50 offen nt lds
    s_add_u32 m0, s59, 15360
    s_add_u32 s50, s54, 114816
    buffer_load_dwordx4 v2, s[44:47], s50 offen nt lds
    s_waitcnt lgkmcnt(0)
    s_barrier
    v_bfe_u32 v5, v0, 3, 1
    v_lshl_add_u32 v8, v5, 13, v8
    s_lshl_b32 s48, s56, 14
    s_lshl_b32 s49, s3, 10
    s_add_u32 s48, s48, s49
    s_add_u32 s48, s48, 1048576
    s_add_u32 s49, s48, 4096
    s_mov_b32 s40, s8
    s_and_b32 s41, s9, 0xffff
    s_mov_b32 s42, 2097152
    s_mov_b32 s43, 0x20000
    s_lshr_b32 s52, s2, 3
    s_lshl_b32 s52, s52, 1
    s_add_u32 s52, s52, s3
    s_lshl_b32 s52, s52, 15
    s_and_b32 s51, s27, 8
    s_add_u32 s51, s51, 3
    s_lshl_b32 s51, s51, 7
    s_add_u32 s52, s52, s51
    v_lshlrev_b32 v5, 11, v0
    s_waitcnt vmcnt(12)
    ds_read_b64_tr_b16 v[64:65], v12 offset:0
    ds_read_b64_tr_b16 v[66:67], v12 offset:2048
    ds_read_b64_tr_b16 v[68:69], v13 offset:0
    ds_read_b64_tr_b16 v[70:71], v13 offset:2048
    ds_read_b64_tr_b16 v[72:73], v14 offset:0
    ds_read_b64_tr_b16 v[74:75], v14 offset:2048
    ds_read_b64_tr_b16 v[76:77], v15 offset:0
    ds_read_b64_tr_b16 v[78:79], v15 offset:2048
    s_sleep 3
    s_mov_b64 exec, 0xffff
    buffer_load_dword v3, v5, s[40:43], s52 offen
    s_mov_b64 exec, -1
    s_mov_b32 s53, 0
L_f_gu:
    buffer_load_dwordx4 v[128:131], v8, s[36:39], s48 offen offset:0 sc1
    buffer_load_dwordx4 v[132:135], v8, s[36:39], s48 offen offset:512 sc1
    buffer_load_dwordx4 v[136:139], v8, s[36:39], s48 offen offset:2048 sc1
    buffer_load_dwordx4 v[140:143], v8, s[36:39], s48 offen offset:2560 sc1
    buffer_load_dwordx4 v[144:147], v8, s[36:39], s49 offen offset:0 sc1
    buffer_load_dwordx4 v[148:151], v8, s[36:39], s49 offen offset:512 sc1
    buffer_load_dwordx4 v[152:155], v8, s[36:39], s49 offen offset:2048 sc1
    buffer_load_dwordx4 v[156:159], v8, s[36:39], s49 offen offset:2560 sc1
    s_cmp_lg_u32 s53, 0
    s_cbranch_scc1 L_f_gu1
    ds_read_b64_tr_b16 v[80:81], v12 offset:4096
    ds_read_b64_tr_b16 v[82:83], v12 offset:6144
    ds_read_b64_tr_b16 v[84:85], v13 offset:4096
    ds_read_b64_tr_b16 v[86:87], v13 offset:6144
    ds_read_b64_tr_b16 v[88:89], v14 offset:4096
    ds_read_b64_tr_b16 v[90:91], v14 offset:6144
    ds_read_b64_tr_b16 v[92:93], v15 offset:4096
    ds_read_b64_tr_b16 v[94:95], v15 offset:6144
    s_waitcnt lgkmcnt(0)
    s_barrier
    s_waitcnt vmcnt(0)
    s_branch L_f_gu2
L_f_gu1:
    s_waitcnt vmcnt(0)
L_f_gu2:
    s_mov_b32 s53, 1
    v_xor_b32 v5, s60, v128
    v_bitop3_b32 v5, v5, v129, s61 bitop3:0xf6
    v_bitop3_b32 v5, v5, v130, s62 bitop3:0xf6
    v_bitop3_b32 v5, v5, v131, s63 bitop3:0xf6
    v_bitop3_b32 v5, v5, v132, s60 bitop3:0xf6
    v_bitop3_b32 v5, v5, v133, s61 bitop3:0xf6
    v_bitop3_b32 v5, v5, v134, s62 bitop3:0xf6
    v_bitop3_b32 v5, v5, v135, s63 bitop3:0xf6
    v_bitop3_b32 v5, v5, v136, s60 bitop3:0xf6
    v_bitop3_b32 v5, v5, v137, s61 bitop3:0xf6
    v_bitop3_b32 v5, v5, v138, s62 bitop3:0xf6
    v_bitop3_b32 v5, v5, v139, s63 bitop3:0xf6
    v_bitop3_b32 v5, v5, v140, s60 bitop3:0xf6
    v_bitop3_b32 v5, v5, v141, s61 bitop3:0xf6
    v_bitop3_b32 v5, v5, v142, s62 bitop3:0xf6
    v_bitop3_b32 v5, v5, v143, s63 bitop3:0xf6
    v_bitop3_b32 v5, v5, v144, s60 bitop3:0xf6
    v_bitop3_b32 v5, v5, v145, s61 bitop3:0xf6
    v_bitop3_b32 v5, v5, v146, s62 bitop3:0xf6
    v_bitop3_b32 v5, v5, v147, s63 bitop3:0xf6
    v_bitop3_b32 v5, v5, v148, s60 bitop3:0xf6
    v_bitop3_b32 v5, v5, v149, s61 bitop3:0xf6
    v_bitop3_b32 v5, v5, v150, s62 bitop3:0xf6
    v_bitop3_b32 v5, v5, v151, s63 bitop3:0xf6
    v_bitop3_b32 v5, v5, v152, s60 bitop3:0xf6
    v_bitop3_b32 v5, v5, v153, s61 bitop3:0xf6
    v_bitop3_b32 v5, v5, v154, s62 bitop3:0xf6
    v_bitop3_b32 v5, v5, v155, s63 bitop3:0xf6
    v_bitop3_b32 v5, v5, v156, s60 bitop3:0xf6
    v_bitop3_b32 v5, v5, v157, s61 bitop3:0xf6
    v_bitop3_b32 v5, v5, v158, s62 bitop3:0xf6
    v_bitop3_b32 v5, v5, v159, s63 bitop3:0xf6
    v_and_b32 v5, 0xff, v5
    v_cmp_ne_u32 vcc, 0, v5
    s_cbranch_vccz L_f_guok
    s_sleep 4
    s_sub_u32 s29, s29, 1
    s_cbranch_scc1 L_end
    s_branch L_f_gu
L_f_guok:
    v_add_f32 v128, v128, v144
    v_add_f32 v129, v129, v145
    v_add_f32 v130, v130, v146
    v_add_f32 v131, v131, v147
    v_add_f32 v132, v132, v148
    v_add_f32 v133, v133, v149
    v_add_f32 v134, v134, v150
    v_add_f32 v135, v135, v151
    v_add_f32 v136, v136, v152
    v_add_f32 v137, v137, v153
    v_add_f32 v138, v138, v154
    v_add_f32 v139, v139, v155
    v_add_f32 v140, v140, v156
    v_add_f32 v141, v141, v157
    v_add_f32 v142, v142, v158
    v_add_f32 v143, v143, v159
    v_add_f32_dpp v128, v128, v128 row_ror:8 row_mask:0xf bank_mask:0xf
    v_add_f32_dpp v129, v129, v129 row_ror:8 row_mask:0xf bank_mask:0xf
    v_add_f32_dpp v130, v130, v130 row_ror:8 row_mask:0xf bank_mask:0xf
    v_add_f32_dpp v131, v131, v131 row_ror:8 row_mask:0xf bank_mask:0xf
    v_add_f32_dpp v132, v132, v132 row_ror:8 row_mask:0xf bank_mask:0xf
    v_add_f32_dpp v133, v133, v133 row_ror:8 row_mask:0xf bank_mask:0xf
    v_add_f32_dpp v134, v134, v134 row_ror:8 row_mask:0xf bank_mask:0xf
    v_add_f32_dpp v135, v135, v135 row_ror:8 row_mask:0xf bank_mask:0xf
    v_add_f32_dpp v136, v136, v136 row_ror:8 row_mask:0xf bank_mask:0xf
    v_add_f32_dpp v137, v137, v137 row_ror:8 row_mask:0xf bank_mask:0xf
    v_add_f32_dpp v138, v138, v138 row_ror:8 row_mask:0xf bank_mask:0xf
    v_add_f32_dpp v139, v139, v139 row_ror:8 row_mask:0xf bank_mask:0xf
    v_add_f32_dpp v140, v140, v140 row_ror:8 row_mask:0xf bank_mask:0xf
    v_add_f32_dpp v141, v141, v141 row_ror:8 row_mask:0xf bank_mask:0xf
    v_add_f32_dpp v142, v142, v142 row_ror:8 row_mask:0xf bank_mask:0xf
    v_add_f32_dpp v143, v143, v143 row_ror:8 row_mask:0xf bank_mask:0xf
    s_waitcnt lgkmcnt(0)
    s_barrier
    v_mul_f32 v144, 0xbfb8aa3b, v128
    v_mul_f32 v145, 0xbfb8aa3b, v129
    v_mul_f32 v146, 0xbfb8aa3b, v130
    v_mul_f32 v147, 0xbfb8aa3b, v131
    v_mul_f32 v148, 0xbfb8aa3b, v132
    v_mul_f32 v149, 0xbfb8aa3b, v133
    v_mul_f32 v150, 0xbfb8aa3b, v134
    v_mul_f32 v151, 0xbfb8aa3b, v135
    v_exp_f32 v144, v144
    v_exp_f32 v145, v145
    v_exp_f32 v146, v146
    v_exp_f32 v147, v147
    v_exp_f32 v148, v148
    v_exp_f32 v149, v149
    v_exp_f32 v150, v150
    v_exp_f32 v151, v151
    v_add_f32 v144, 1.0, v144
    v_add_f32 v145, 1.0, v145
    v_add_f32 v146, 1.0, v146
    v_add_f32 v147, 1.0, v147
    v_add_f32 v148, 1.0, v148
    v_add_f32 v149, 1.0, v149
    v_add_f32 v150, 1.0, v150
    v_add_f32_e64 v151, 1.0, v151
    s_waitcnt vmcnt(0)
    ds_read_b64_tr_b16 v[96:97], v12 offset:8192
    ds_read_b64_tr_b16 v[98:99], v12 offset:10240
    ds_read_b64_tr_b16 v[100:101], v13 offset:8192
    ds_read_b64_tr_b16 v[102:103], v13 offset:10240
    ds_read_b64_tr_b16 v[104:105], v14 offset:8192
    ds_read_b64_tr_b16 v[106:107], v14 offset:10240
    ds_read_b64_tr_b16 v[108:109], v15 offset:8192
    ds_read_b64_tr_b16 v[110:111], v15 offset:10240
    v_rcp_f32 v144, v144
    v_rcp_f32 v145, v145
    v_rcp_f32 v146, v146
    v_rcp_f32 v147, v147
    v_rcp_f32 v148, v148
    v_rcp_f32 v149, v149
    v_rcp_f32 v150, v150
    v_rcp_f32 v151, v151
    v_mul_f32 v128, v128, v136
    v_mul_f32 v129, v129, v137
    v_mul_f32 v130, v130, v138
    v_mul_f32 v131, v131, v139
    v_mul_f32 v132, v132, v140
    v_mul_f32 v133, v133, v141
    v_mul_f32 v134, v134, v142
    v_mul_f32 v135, v135, v143
    v_mul_f32 v128, v128, v144
    v_mul_f32 v129, v129, v145
    v_mul_f32 v130, v130, v146
    v_mul_f32 v131, v131, v147
    v_mul_f32 v132, v132, v148
    v_mul_f32 v133, v133, v149
    v_mul_f32 v134, v134, v150
    v_mul_f32 v135, v135, v151
    v_cvt_pk_bf16_f32 v16, v128, v129
    v_cvt_pk_bf16_f32 v17, v130, v131
    v_cvt_pk_bf16_f32 v18, v132, v133
    v_cvt_pk_bf16_f32 v19, v134, v135
    s_lshl_b32 s48, s3, 10
    s_add_u32 s48, s48, 131072
    v_add_u32 v5, s48, v1
    v_add_u32 v10, 131072, v1
    ds_write_b128 v5, v[16:19]
    s_waitcnt lgkmcnt(0)
    s_barrier
    s_add_u32 s59, s59, 12288
    v_add_u32 v3, s59, v1
    v_bfe_u32 v5, v0, 3, 1
    v_lshl_add_u32 v5, v5, 2, v7
    v_xor_b32 v5, v5, v6
    v_lshlrev_b32 v5, 4, v5
    v_lshl_add_u32 v5, v6, 9, v5
    v_add_u32 v5, s59, v5
    v_lshrrev_b32 v24, 5, v0
    v_mul_u32_u24 v25, 14336, v24
    v_bfe_u32 v26, v0, 4, 1
    v_mul_u32_u24 v26, 114688, v26
    v_and_b32 v27, 15, v0
    v_xor_b32 v27, v27, v24
    v_lshlrev_b32 v27, 4, v27
    v_add3_u32 v8, v25, v26, v27
    s_lshl_b32 s48, s57, 1
    s_add_u32 s48, s48, s3
    s_mul_i32 s48, s48, 229376
    s_lshl_b32 s49, s56, 8
    s_add_u32 s48, s48, s49
    s_add_u32 s48, s48, 2097152
    ds_read_b128 v[16:19], v10
    ds_read_b128 v[20:23], v10 offset:1024
    ds_read_b64_tr_b16 v[112:113], v12 offset:12288
    ds_read_b64_tr_b16 v[114:115], v12 offset:14336
    ds_read_b64_tr_b16 v[116:117], v13 offset:12288
    ds_read_b64_tr_b16 v[118:119], v13 offset:14336
    ds_read_b64_tr_b16 v[120:121], v14 offset:12288
    ds_read_b64_tr_b16 v[122:123], v14 offset:14336
    ds_read_b64_tr_b16 v[124:125], v15 offset:12288
    ds_read_b64_tr_b16 v[126:127], v15 offset:14336
    s_waitcnt lgkmcnt(0)
    s_setprio 3
    v_mfma_f32_16x16x32_bf16 v[128:131], v[64:67], v[16:19], 0
    v_mfma_f32_16x16x32_bf16 v[132:135], v[68:71], v[16:19], 0
    v_mfma_f32_16x16x32_bf16 v[136:139], v[72:75], v[16:19], 0
    v_mfma_f32_16x16x32_bf16 v[140:143], v[76:79], v[16:19], 0
    v_mfma_f32_16x16x32_bf16 v[144:147], v[96:99], v[16:19], 0
    v_mfma_f32_16x16x32_bf16 v[148:151], v[100:103], v[16:19], 0
    v_mfma_f32_16x16x32_bf16 v[152:155], v[104:107], v[16:19], 0
    v_mfma_f32_16x16x32_bf16 v[156:159], v[108:111], v[16:19], 0
    v_mfma_f32_16x16x32_bf16 v[128:131], v[80:83], v[20:23], v[128:131]
    v_mfma_f32_16x16x32_bf16 v[132:135], v[84:87], v[20:23], v[132:135]
    v_mfma_f32_16x16x32_bf16 v[136:139], v[88:91], v[20:23], v[136:139]
    v_mfma_f32_16x16x32_bf16 v[140:143], v[92:95], v[20:23], v[140:143]
    v_mfma_f32_16x16x32_bf16 v[144:147], v[112:115], v[20:23], v[144:147]
    v_mfma_f32_16x16x32_bf16 v[148:151], v[116:119], v[20:23], v[148:151]
    v_mfma_f32_16x16x32_bf16 v[152:155], v[120:123], v[20:23], v[152:155]
    v_mfma_f32_16x16x32_bf16 v[156:159], v[124:127], v[20:23], v[156:159]
    s_setprio 0
    s_nop 0
    v_mov_b32_dpp v128, v132 row_ror:8 row_mask:0xf bank_mask:0xc
    v_mov_b32_dpp v129, v133 row_ror:8 row_mask:0xf bank_mask:0xc
    v_mov_b32_dpp v130, v134 row_ror:8 row_mask:0xf bank_mask:0xc
    v_mov_b32_dpp v131, v135 row_ror:8 row_mask:0xf bank_mask:0xc
    v_mov_b32_dpp v136, v140 row_ror:8 row_mask:0xf bank_mask:0xc
    v_mov_b32_dpp v137, v141 row_ror:8 row_mask:0xf bank_mask:0xc
    v_mov_b32_dpp v138, v142 row_ror:8 row_mask:0xf bank_mask:0xc
    v_mov_b32_dpp v139, v143 row_ror:8 row_mask:0xf bank_mask:0xc
    v_mov_b32_dpp v144, v148 row_ror:8 row_mask:0xf bank_mask:0xc
    v_mov_b32_dpp v145, v149 row_ror:8 row_mask:0xf bank_mask:0xc
    v_mov_b32_dpp v146, v150 row_ror:8 row_mask:0xf bank_mask:0xc
    v_mov_b32_dpp v147, v151 row_ror:8 row_mask:0xf bank_mask:0xc
    v_mov_b32_dpp v152, v156 row_ror:8 row_mask:0xf bank_mask:0xc
    v_mov_b32_dpp v153, v157 row_ror:8 row_mask:0xf bank_mask:0xc
    v_mov_b32_dpp v154, v158 row_ror:8 row_mask:0xf bank_mask:0xc
    v_mov_b32_dpp v155, v159 row_ror:8 row_mask:0xf bank_mask:0xc
    v_and_or_b32 v128, v128, v9, s60
    v_and_or_b32 v129, v129, v9, s61
    v_and_or_b32 v130, v130, v9, s62
    v_and_or_b32 v131, v131, v9, s63
    v_and_or_b32 v136, v136, v9, s60
    v_and_or_b32 v137, v137, v9, s61
    v_and_or_b32 v138, v138, v9, s62
    v_and_or_b32 v139, v139, v9, s63
    v_and_or_b32 v144, v144, v9, s60
    v_and_or_b32 v145, v145, v9, s61
    v_and_or_b32 v146, v146, v9, s62
    v_and_or_b32 v147, v147, v9, s63
    v_and_or_b32 v152, v152, v9, s60
    v_and_or_b32 v153, v153, v9, s61
    v_and_or_b32 v154, v154, v9, s62
    v_and_or_b32 v155, v155, v9, s63
    ds_write_b128 v5, v[128:131] offset:0
    ds_write_b128 v5, v[136:139] offset:128
    ds_write_b128 v5, v[144:147] offset:256
    ds_write_b128 v5, v[152:155] offset:384
    ds_read_b128 v[160:163], v3 offset:0
    ds_read_b128 v[164:167], v3 offset:1024
    ds_read_b128 v[168:171], v3 offset:2048
    ds_read_b128 v[172:175], v3 offset:3072
    v_xor_b32 v12, 0, v8
    s_waitcnt lgkmcnt(3)
    buffer_store_dwordx4 v[160:163], v12, s[36:39], s48 offen sc1
    s_add_u32 s48, s48, 28672
    v_xor_b32 v12, 32, v8
    s_waitcnt lgkmcnt(2)
    buffer_store_dwordx4 v[164:167], v12, s[36:39], s48 offen sc1
    s_add_u32 s48, s48, 28672
    v_xor_b32 v12, 64, v8
    s_waitcnt lgkmcnt(1)
    buffer_store_dwordx4 v[168:171], v12, s[36:39], s48 offen sc1
    s_add_u32 s48, s48, 28672
    v_xor_b32 v12, 96, v8
    s_waitcnt lgkmcnt(0)
    buffer_store_dwordx4 v[172:175], v12, s[36:39], s48 offen sc1
    s_add_u32 s48, s48, 28672
    s_waitcnt lgkmcnt(0)
    s_barrier
    s_branch L_f_upd
L_f_idle:
    s_waitcnt lgkmcnt(0)
    s_barrier
    s_barrier
    s_barrier
    s_barrier
    s_mov_b32 s40, s8
    s_and_b32 s41, s9, 0xffff
    s_mov_b32 s42, 2097152
    s_mov_b32 s43, 0x20000
    s_lshr_b32 s52, s2, 3
    s_lshl_b32 s52, s52, 1
    s_add_u32 s52, s52, s3
    s_lshl_b32 s52, s52, 15
    s_and_b32 s51, s27, 8
    s_add_u32 s51, s51, 3
    s_lshl_b32 s51, s51, 7
    s_add_u32 s52, s52, s51
    v_lshlrev_b32 v5, 11, v0
    s_sleep 10
    s_mov_b64 exec, 0xffff
    buffer_load_dword v3, v5, s[40:43], s52 offen
    s_mov_b64 exec, -1
    s_barrier
    s_barrier
    s_barrier
    s_barrier
    s_barrier
L_f_upd:
    v_lshlrev_b32 v6, 2, v6
    ds_read_b32 v12, v6 offset:1408
    s_waitcnt lgkmcnt(0)
    v_not_b32 v5, v12
    v_bfe_u32 v5, v5, 7, 4
    v_cmp_eq_u32 vcc, s26, v5
    s_and_b32 s52, vcc_lo, 0xff
    s_cbranch_scc0 L_f_done
    v_ashrrev_i32 v13, 31, v12
    v_not_b32 v13, v13
    v_or_b32 v13, 0x80000000, v13
    v_xor_b32 v12, v12, v13
    v_and_b32 v12, 0xffff0000, v12
    v_mul_f32 v12, 0xbfb8aa3b, v12
    v_exp_f32 v12, v12
    s_nop 0
    v_add_f32 v12, 1.0, v12
    v_rcp_f32 v12, v12
    v_mov_b32 v5, 0
    s_mul_i32 s55, s3, 7168
    s_add_u32 s55, s55, 2097152
    s_lshl_b32 s51, s3, 11
    s_add_u32 s51, s51, 155648
L_lw_12:
    ds_read_b32 v10, v5 offset:152
    s_waitcnt lgkmcnt(0)
    v_cmp_gt_u32 vcc, 4, v10
    s_cbranch_vccz L_lwe_13
    s_sleep 2
    s_sub_u32 s29, s29, 1
    s_cbranch_scc1 L_end
    s_branch L_lw_12
    s_nop 0
L_lwe_13:
    s_setprio 3
L_f_tok:
    s_ff1_i32_b32 s53, s52
    s_bitset0_b32 s52, s53
    v_readlane_b32 s50, v12, s53
    s_lshl_b32 s48, s27, 3
    s_add_u32 s48, s48, s53
    s_mul_i32 s54, s48, 14336
    s_add_u32 s54, s54, s55
    s_add_u32 s49, s54, 4096
    s_lshl_b32 s48, s53, 8
    s_add_u32 s48, s48, s51
L_f_y:
    buffer_load_dwordx4 v[128:131], v1, s[36:39], s54 offen offset:0 sc1
    buffer_load_dwordx4 v[132:135], v1, s[36:39], s54 offen offset:1024 sc1
    buffer_load_dwordx4 v[136:139], v1, s[36:39], s54 offen offset:2048 sc1
    buffer_load_dwordx4 v[140:143], v1, s[36:39], s54 offen offset:3072 sc1
    buffer_load_dwordx4 v[144:147], v1, s[36:39], s49 offen offset:0 sc1
    buffer_load_dwordx4 v[148:151], v1, s[36:39], s49 offen offset:1024 sc1
    buffer_load_dwordx4 v[152:155], v1, s[36:39], s49 offen offset:2048 sc1
    s_waitcnt vmcnt(0)
    v_xor_b32 v5, s60, v128
    v_bitop3_b32 v5, v5, v129, s61 bitop3:0xf6
    v_bitop3_b32 v5, v5, v130, s62 bitop3:0xf6
    v_bitop3_b32 v5, v5, v131, s63 bitop3:0xf6
    v_bitop3_b32 v5, v5, v132, s60 bitop3:0xf6
    v_bitop3_b32 v5, v5, v133, s61 bitop3:0xf6
    v_bitop3_b32 v5, v5, v134, s62 bitop3:0xf6
    v_bitop3_b32 v5, v5, v135, s63 bitop3:0xf6
    v_bitop3_b32 v5, v5, v136, s60 bitop3:0xf6
    v_bitop3_b32 v5, v5, v137, s61 bitop3:0xf6
    v_bitop3_b32 v5, v5, v138, s62 bitop3:0xf6
    v_bitop3_b32 v5, v5, v139, s63 bitop3:0xf6
    v_bitop3_b32 v5, v5, v140, s60 bitop3:0xf6
    v_bitop3_b32 v5, v5, v141, s61 bitop3:0xf6
    v_bitop3_b32 v5, v5, v142, s62 bitop3:0xf6
    v_bitop3_b32 v5, v5, v143, s63 bitop3:0xf6
    v_bitop3_b32 v5, v5, v144, s60 bitop3:0xf6
    v_bitop3_b32 v5, v5, v145, s61 bitop3:0xf6
    v_bitop3_b32 v5, v5, v146, s62 bitop3:0xf6
    v_bitop3_b32 v5, v5, v147, s63 bitop3:0xf6
    v_bitop3_b32 v5, v5, v148, s60 bitop3:0xf6
    v_bitop3_b32 v5, v5, v149, s61 bitop3:0xf6
    v_bitop3_b32 v5, v5, v150, s62 bitop3:0xf6
    v_bitop3_b32 v5, v5, v151, s63 bitop3:0xf6
    v_bitop3_b32 v5, v5, v152, s60 bitop3:0xf6
    v_bitop3_b32 v5, v5, v153, s61 bitop3:0xf6
    v_bitop3_b32 v5, v5, v154, s62 bitop3:0xf6
    v_bitop3_b32 v5, v5, v155, s63 bitop3:0xf6
    v_and_b32 v5, 0xff, v5
    v_cmp_ne_u32 vcc, 0, v5
    s_cbranch_vccz L_f_yok
    s_sleep 8
    s_sub_u32 s29, s29, 1
    s_cbranch_scc1 L_end
    s_branch L_f_y
L_f_yok:
    v_add_f32 v128, v128, v132
    v_add_f32 v129, v129, v133
    v_add_f32 v130, v130, v134
    v_add_f32 v131, v131, v135
    v_add_f32 v128, v128, v136
    v_add_f32 v129, v129, v137
    v_add_f32 v130, v130, v138
    v_add_f32 v131, v131, v139
    v_add_f32 v128, v128, v140
    v_add_f32 v129, v129, v141
    v_add_f32 v130, v130, v142
    v_add_f32 v131, v131, v143
    v_add_f32 v128, v128, v144
    v_add_f32 v129, v129, v145
    v_add_f32 v130, v130, v146
    v_add_f32 v131, v131, v147
    v_add_f32 v128, v128, v148
    v_add_f32 v129, v129, v149
    v_add_f32 v130, v130, v150
    v_add_f32 v131, v131, v151
    v_add_f32 v128, v128, v152
    v_add_f32 v129, v129, v153
    v_add_f32 v130, v130, v154
    v_add_f32 v131, v131, v155
    v_permlane16_swap_b32 v128, v129
    s_nop 0
    v_permlane16_swap_b32 v130, v131
    v_add_f32 v128, v128, v129
    v_add_f32 v130, v130, v131
    v_and_b32 v13, 15, v0
    v_lshlrev_b32 v13, 4, v13
    v_permlane32_swap_b32 v128, v130
    v_lshl_add_u32 v13, v7, 2, v13
    v_add_f32 v128, v128, v130
    v_add_u32 v13, s48, v13
    v_mul_f32 v128, s50, v128
    ds_write_b32 v13, v128
    s_waitcnt lgkmcnt(0)
    s_cmp_lg_u32 s52, 0
    s_cbranch_scc1 L_f_tok
L_f_done:
    ds_write_b32 v4, v4 offset:16
L_end:
    s_endpgm
L_code_end:
.section .rodata,"a"
.p2align 6
.amdhsa_kernel parallel_sum__sliding_local_dilated__moe_arch_mod__prompt_kernel
  .amdhsa_next_free_vgpr 256
  .amdhsa_next_free_sgpr 102
  .amdhsa_accum_offset 256
  .amdhsa_group_segment_fixed_size 0
  .amdhsa_kernarg_size 88
  .amdhsa_user_sgpr_count 2
  .amdhsa_user_sgpr_kernarg_segment_ptr 1
  .amdhsa_system_sgpr_workgroup_id_x 1
  .amdhsa_float_denorm_mode_32 3
.end_amdhsa_kernel
```
